```python
import torch

def _softmax(x, axis=-1):
    return torch.softmax(x, dim=axis)
def _gelu(x):
    return torch.nn.functional.gelu(x, approximate="tanh")
def _silu(x):
    return torch.nn.functional.silu(x)
def _sigmoid(x):
    return torch.sigmoid(x)
def _layernorm(x, axis=-1, eps=1e-5):
    m = x.mean(dim=axis, keepdim=True)
    v = x.var(dim=axis, keepdim=True, unbiased=False)
    return (x - m) / torch.sqrt(v + eps)
def _scatter_add(tgt, idx, src, axis=0):
    return tgt.clone().index_add_(axis, idx, src)
def _segment_sum(src, seg, n):
    out = torch.zeros((n,) + src.shape[1:], dtype=src.dtype)
    return out.index_add_(0, seg, src)
def _pad(x, pw):
    flat = tuple(v for pair in reversed(pw) for v in pair)
    return torch.nn.functional.pad(x, flat)

kernel_name = 'gated_mix__mha_block_cached__compressed_kv_cla__decode'

def setup_inputs():

    _w = (lambda a: (lambda t: t.to(torch.bfloat16) if t.is_floating_point() else t)(torch.as_tensor(a)))
    def _A_setup():
        B, Sq, D = 2, 1, 512
        H, Sk, Dh = 32, 8192, 128
        return {
            "x": _w((lambda *s: torch.randn(*s, dtype=torch.bfloat16) * 0.05)(B, Sq, D)),
            "k_cache": _w((lambda *s: torch.randn(*s, dtype=torch.bfloat16) * 6.4)(B, H, Sk, Dh)),
            "v_cache": _w((lambda *s: torch.randn(*s, dtype=torch.bfloat16) * 3.2)(B, H, Sk, Dh)),
            "wq": _w((lambda *s: torch.randn(*s, dtype=torch.bfloat16) * 6.4)(D, H * Dh) * (D ** -0.5)),
            "wo": _w((lambda *s: torch.randn(*s, dtype=torch.bfloat16) * 3.2)(H * Dh, D) * ((H * Dh) ** -0.5)),
        }
    _A_in = _A_setup()

    def _B_setup():
        B, H, Sq, Sk, D, M = 2, 32, 1, 8192, 128, 512
        Dc = 4 * D
        return {
            "x": _w((lambda *s: torch.randn(*s, dtype=torch.bfloat16) * 0.05)(B, Sq, M)),
            "c_kv": _w((lambda *s: torch.randn(*s, dtype=torch.bfloat16) * 1.6)(B, Sk, Dc)),
            "w_q": _w((lambda *s: torch.randn(*s, dtype=torch.bfloat16) * 6.4)(M, H, D) * (M ** -0.5)),
            "w_uk": _w((lambda *s: torch.randn(*s, dtype=torch.bfloat16) * 6.4)(Dc, H, D) * (Dc ** -0.5)),
            "w_uv": _w((lambda *s: torch.randn(*s, dtype=torch.bfloat16) * 1.6)(Dc, H, D) * (Dc ** -0.5)),
            "w_o": _w((lambda *s: torch.randn(*s, dtype=torch.bfloat16) * 1.6)(H, D, M) * ((H * D) ** -0.5)),
        }
    _B_in = _B_setup()

    return {
        "A_x": _A_in["x"],
        "A_k_cache": _A_in["k_cache"],
        "A_v_cache": _A_in["v_cache"],
        "A_wq": _A_in["wq"],
        "A_wo": _A_in["wo"],
        "B_x": _B_in["x"],
        "B_c_kv": _B_in["c_kv"],
        "B_w_q": _B_in["w_q"],
        "B_w_uk": _B_in["w_uk"],
        "B_w_uv": _B_in["w_uv"],
        "B_w_o": _B_in["w_o"],
        "gate_w": _w((lambda *s: torch.randn(*s, dtype=torch.bfloat16) * 0.1)(512) * 16.0),
    }

def reference(A_x, A_k_cache, A_v_cache, A_wq, A_wo, B_x, B_c_kv, B_w_q, B_w_uk, B_w_uv, B_w_o, gate_w):
    def _A_ref(x, k_cache, v_cache, wq, wo):
        B, Sq, D = x.shape
        H, Dh = 32, 128
        q = (lambda x, *d: x.permute(*d))((x @ wq).reshape(B, Sq, H, Dh), 0, 2, 1, 3)
        scores = torch.einsum("bhqd,bhkd->bhqk", q, k_cache) * (Dh ** -0.5)
        p = _softmax(scores, axis=-1)
        o = torch.einsum("bhqk,bhkd->bhqd", p, v_cache)
        return (lambda x, *d: x.permute(*d))(o, 0, 2, 1, 3).reshape(B, Sq, H * Dh) @ wo

    def _B_ref(x, c_kv, w_q, w_uk, w_uv, w_o):
        B, Sq, M = x.shape[0], x.shape[1], x.shape[2]
        Sk = c_kv.shape[1]
        H, D = w_q.shape[1], w_q.shape[2]
        q = torch.einsum("bqm,mhd->bhqd", x, w_q)
        k = torch.einsum("bkc,chd->bhkd", c_kv, w_uk)
        v = torch.einsum("bkc,chd->bhkd", c_kv, w_uv)
        scores = torch.einsum("bhqd,bhkd->bhqk", q, k) * (D ** -0.5)
        off = Sk - Sq
        qi = torch.arange(Sq)[:, None]
        kj = torch.arange(Sk)[None, :]
        cmask = kj <= (qi + off)
        scores = torch.where(cmask[None, None], scores, -1e9)
        p = _softmax(scores, axis=-1)
        ctx = torch.einsum("bhqk,bhkd->bhqd", p, v)
        return torch.einsum("bhqd,hdm->bqm", ctx, w_o)

    x = A_x
    g = _sigmoid((x * gate_w).sum(-1, keepdims=True))
    a = _A_ref(x, A_k_cache, A_v_cache, A_wq, A_wo)
    b = _B_ref(x, B_c_kv, B_w_q, B_w_uk, B_w_uv, B_w_o)
    return g * a + (1 - g) * b
```

```asm
; @launch grid=(256,1,1) block=(512,1,1) lds=153344
.amdgcn_target "amdgcn-amd-amdhsa--gfx950"
.text
.globl gated_mix__mha_block_cached__compressed_kv_cla__decode_kernel
.p2align 8
.type gated_mix__mha_block_cached__compressed_kv_cla__decode_kernel,@function
gated_mix__mha_block_cached__compressed_kv_cla__decode_kernel:
  s_cmp_ge_u32 s2, 256
  s_cbranch_scc1 L_end
  s_load_dwordx16 s[32:47], s[0:1], 0
  s_load_dwordx8 s[48:55], s[0:1], 64
  s_load_dwordx4 s[56:59], s[0:1], 96
  s_load_dwordx2 s[60:61], s[0:1], 112
  v_lshrrev_b32 v1, 6, v0
  v_and_b32 v0, 63, v0
  v_readfirstlane_b32 s3, v1
  v_lshlrev_b32 v2, 4, v0
  v_lshrrev_b32 v3, 4, v0
  v_and_b32 v4, 15, v0
  v_and_b32 v1, 7, v0
  s_mov_b32 s26, 0x3db504f3
  s_and_b32 s63, s3, 3
  s_mov_b32 s81, 1048576
  s_cmp_lt_u32 s2, 64
  s_waitcnt lgkmcnt(0)
  s_load_dword s7, s[60:61], s81
  s_mov_b32 s16, s60
  s_mov_b32 s17, s61
  s_mov_b32 s18, 0x800000
  s_mov_b32 s19, 0x20000
  s_cbranch_scc1 L_bwg
  s_cmp_ge_u32 s3, 4
  s_cbranch_scc1 L_sexit
  s_sub_u32 s24, s2, 64
  s_mul_i32 s62, s24, 43691
  s_lshr_b32 s62, s62, 17
  s_mul_i32 s25, s62, 3
  s_sub_u32 s6, s24, s25
  s_and_b32 s62, s24, 63
  s_lshr_b32 s6, s24, 6
  s_mov_b32 s87, 0
  s_mov_b32 s85, 1
L_stream:
  s_mov_b32 s8, s34
  s_mov_b32 s9, s35
  s_mov_b32 s10, 0x8000000
  s_mov_b32 s11, 0x20000
  s_mov_b32 s12, s36
  s_mov_b32 s13, s37
  s_mov_b32 s14, 0x8000000
  s_mov_b32 s15, 0x20000
  s_mov_b32 s25, 39
  s_mov_b32 s24, 0
  s_cmp_eq_u32 s6, 1
  s_cselect_b32 s25, 39, s25
  s_cselect_b32 s24, 156, s24
  s_cmp_eq_u32 s6, 2
  s_cselect_b32 s25, 38, s25
  s_cselect_b32 s24, 312, s24
  s_cmp_eq_u32 s6, 3
  s_cselect_b32 s25, 24, s25
  s_cselect_b32 s24, 464, s24
  s_mul_i32 s27, s25, s63
  s_add_u32 s24, s24, s27
  s_lshl_b32 s24, s24, 12
  s_lshl_b32 s25, s25, 12
  s_lshl_b32 s65, s62, 21
  s_add_u32 s65, s65, s24
  s_add_u32 s66, s65, s25
  s_lshl_b32 s84, s62, 8
  s_add_u32 s84, s84, 1093632
  s_lshl_b32 s24, s6, 2
  s_add_u32 s24, s24, s63
  s_mul_i32 s65, s24, 5
  s_lshl_b32 s66, s62, 21
  s_mul_i32 s80, s62, 0
  s_movk_i32 s64, 512
  s_mov_b32 s83, 4
  s_mov_b32 s82, 60
  s_mov_b32 s27, 5
  s_mul_i32 s24, s63, 16
  s_add_u32 s24, s24, 360
  s_cmp_eq_u32 s6, 3
  s_cselect_b32 s64, 0, s64
  s_cselect_b32 s65, s24, s65
  s_cselect_b32 s83, 2, s83
  s_cselect_b32 s82, 5, s82
  s_cselect_b32 s27, 1, s27
  s_mul_i32 s24, s63, 5
  s_add_u32 s24, s24, 392
  s_cmp_eq_u32 s6, 4
  s_cselect_b32 s64, 0, s64
  s_cselect_b32 s65, s24, s65
  s_cselect_b32 s83, 0, s83
  s_cselect_b32 s82, 5, s82
  s_cselect_b32 s27, 0, s27
  s_add_u32 s25, s83, 1
  s_mul_i32 s25, s25, s82
  s_add_u32 s25, s25, s65
  s_sub_u32 s82, s82, 4
  v_mov_b32 v52, s25
  s_cmp_gt_u32 s27, 0
  s_cselect_b32 s74, 0, 512
  s_add_u32 s25, s25, 1
  v_mov_b32 v53, s25
  s_cmp_gt_u32 s27, 1
  s_cselect_b32 s75, 0, 512
  s_add_u32 s25, s25, 1
  v_mov_b32 v54, s25
  s_cmp_gt_u32 s27, 2
  s_cselect_b32 s76, 0, 512
  s_add_u32 s25, s25, 1
  v_mov_b32 v55, s25
  s_cmp_gt_u32 s27, 3
  s_cselect_b32 s77, 0, 512
  s_add_u32 s25, s25, 1
  v_mov_b32 v56, s25
  s_cmp_gt_u32 s27, 4
  s_cselect_b32 s78, 0, 512
  s_add_u32 s25, s25, 1
  s_add_u32 s25, s65, s80
  s_and_b32 s25, s25, 511
  s_lshl_b32 s25, s25, 12
  s_add_u32 s25, s25, s66
  s_mov_b32 s68, s25
  s_add_u32 s65, s65, 1
  buffer_load_dwordx4 v[64:67], v2, s[8:11], s68 offen offset:0 nt
  buffer_load_dwordx4 v[68:71], v2, s[8:11], s68 offen offset:1024 nt
  buffer_load_dwordx4 v[72:75], v2, s[8:11], s68 offen offset:2048 nt
  buffer_load_dwordx4 v[76:79], v2, s[8:11], s68 offen offset:3072 nt
  buffer_load_dwordx4 v[80:83], v2, s[12:15], s68 offen offset:0 nt
  buffer_load_dwordx4 v[84:87], v2, s[12:15], s68 offen offset:1024 nt
  buffer_load_dwordx4 v[88:91], v2, s[12:15], s68 offen offset:2048 nt
  buffer_load_dwordx4 v[92:95], v2, s[12:15], s68 offen offset:3072 nt
  s_add_u32 s25, s65, s80
  s_and_b32 s25, s25, 511
  s_lshl_b32 s25, s25, 12
  s_add_u32 s25, s25, s66
  s_mov_b32 s69, s25
  s_add_u32 s65, s65, 1
  buffer_load_dwordx4 v[96:99], v2, s[8:11], s69 offen offset:0 nt
  buffer_load_dwordx4 v[100:103], v2, s[8:11], s69 offen offset:1024 nt
  buffer_load_dwordx4 v[104:107], v2, s[8:11], s69 offen offset:2048 nt
  buffer_load_dwordx4 v[108:111], v2, s[8:11], s69 offen offset:3072 nt
  buffer_load_dwordx4 v[112:115], v2, s[12:15], s69 offen offset:0 nt
  buffer_load_dwordx4 v[116:119], v2, s[12:15], s69 offen offset:1024 nt
  buffer_load_dwordx4 v[120:123], v2, s[12:15], s69 offen offset:2048 nt
  buffer_load_dwordx4 v[124:127], v2, s[12:15], s69 offen offset:3072 nt
  s_add_u32 s25, s65, s80
  s_and_b32 s25, s25, 511
  s_lshl_b32 s25, s25, 12
  s_add_u32 s25, s25, s66
  s_mov_b32 s70, s25
  s_add_u32 s65, s65, 1
  buffer_load_dwordx4 v[128:131], v2, s[8:11], s70 offen offset:0 nt
  buffer_load_dwordx4 v[132:135], v2, s[8:11], s70 offen offset:1024 nt
  buffer_load_dwordx4 v[136:139], v2, s[8:11], s70 offen offset:2048 nt
  buffer_load_dwordx4 v[140:143], v2, s[8:11], s70 offen offset:3072 nt
  buffer_load_dwordx4 v[144:147], v2, s[12:15], s70 offen offset:0 nt
  buffer_load_dwordx4 v[148:151], v2, s[12:15], s70 offen offset:1024 nt
  buffer_load_dwordx4 v[152:155], v2, s[12:15], s70 offen offset:2048 nt
  buffer_load_dwordx4 v[156:159], v2, s[12:15], s70 offen offset:3072 nt
  s_add_u32 s25, s65, s80
  s_and_b32 s25, s25, 511
  s_lshl_b32 s25, s25, 12
  s_add_u32 s25, s25, s66
  s_mov_b32 s71, s25
  s_add_u32 s65, s65, 1
  buffer_load_dwordx4 v[160:163], v2, s[8:11], s71 offen offset:0 nt
  buffer_load_dwordx4 v[164:167], v2, s[8:11], s71 offen offset:1024 nt
  buffer_load_dwordx4 v[168:171], v2, s[8:11], s71 offen offset:2048 nt
  buffer_load_dwordx4 v[172:175], v2, s[8:11], s71 offen offset:3072 nt
  buffer_load_dwordx4 v[176:179], v2, s[12:15], s71 offen offset:0 nt
  buffer_load_dwordx4 v[180:183], v2, s[12:15], s71 offen offset:1024 nt
  buffer_load_dwordx4 v[184:187], v2, s[12:15], s71 offen offset:2048 nt
  buffer_load_dwordx4 v[188:191], v2, s[12:15], s71 offen offset:3072 nt
  s_add_u32 s25, s65, s80
  s_and_b32 s25, s25, 511
  s_lshl_b32 s25, s25, 12
  s_add_u32 s25, s25, s66
  s_mov_b32 s72, s25
  s_add_u32 s65, s65, s82
  buffer_load_dwordx4 v[192:195], v2, s[8:11], s72 offen offset:0 nt
  buffer_load_dwordx4 v[196:199], v2, s[8:11], s72 offen offset:1024 nt
  buffer_load_dwordx4 v[200:203], v2, s[8:11], s72 offen offset:2048 nt
  buffer_load_dwordx4 v[204:207], v2, s[8:11], s72 offen offset:3072 nt
  buffer_load_dwordx4 v[208:211], v2, s[12:15], s72 offen offset:0 nt
  buffer_load_dwordx4 v[212:215], v2, s[12:15], s72 offen offset:1024 nt
  buffer_load_dwordx4 v[216:219], v2, s[12:15], s72 offen offset:2048 nt
  buffer_load_dwordx4 v[220:223], v2, s[12:15], s72 offen offset:3072 nt
  v_and_b32 v17, 1, v4
  v_lshlrev_b32 v17, 4, v17
  v_mov_b32 v18, 0xffff
  v_lshlrev_b32 v17, v17, v18
  v_lshrrev_b32 v18, 1, v4
  v_cmp_eq_u32 vcc, 0, v18
  s_nop 1
  v_cndmask_b32 v5, 0, v17, vcc
  v_cmp_eq_u32 vcc, 1, v18
  s_nop 1
  v_cndmask_b32 v6, 0, v17, vcc
  v_cmp_eq_u32 vcc, 2, v18
  s_nop 1
  v_cndmask_b32 v7, 0, v17, vcc
  v_cmp_eq_u32 vcc, 3, v18
  s_nop 1
  v_cndmask_b32 v8, 0, v17, vcc
  v_mov_b32 v19, 0xf149f2ca
  v_mov_b32 v24, 0
  s_cmp_lt_u32 s2, 64
  s_cbranch_scc1 L_sq
  s_cmp_lg_u32 s3, 0
  s_cbranch_scc1 L_noz0
  v_mov_b32 v28, 153088
  v_lshl_add_u32 v28, v4, 2, v28
  v_mov_b32 v29, 0
  ds_write_b32 v28, v29
L_noz0:
  s_waitcnt lgkmcnt(0)
  s_barrier
  s_add_u32 s7, s7, 0x9e3779b1
L_sq:
  s_lshl_b32 s67, s62, 9
  s_add_u32 s67, s67, 1052672
  v_lshlrev_b32 v21, 5, v4
  s_mov_b32 s30, 50000
L_gp1:
  buffer_load_dwordx4 v[32:35], v21, s[16:19], s67 offen sc1
  buffer_load_dwordx4 v[36:39], v21, s[16:19], s67 offen offset:16 sc1
  s_waitcnt vmcnt(0)
  v_mov_b32 v28, v33
  v_mov_b32 v29, v33
  v_min3_u32 v28, v28, v35, v37
  v_max3_u32 v29, v29, v35, v37
  v_min3_u32 v28, v28, v39, v39
  v_max3_u32 v29, v29, v39, v39
  v_cmp_eq_u32 s[24:25], s7, v28
  v_cmp_eq_u32 vcc, s7, v29
  s_and_b64 vcc, vcc, s[24:25]
  s_cmp_eq_u64 vcc, -1
  s_cbranch_scc1 L_gpd2
  s_sleep 2
  s_sub_u32 s30, s30, 1
  s_cmp_lg_u32 s30, 0
  s_cbranch_scc1 L_gp1
L_gpd2:
  v_mov_b32 v9, v32
  v_mov_b32 v10, v34
  v_mov_b32 v11, v36
  v_mov_b32 v12, v38
  v_mov_b32 v28, 0
  v_mov_b32 v29, 0
  v_mov_b32 v30, 0
  v_mov_b32 v31, 0
L_loopa:
  s_cmp_eq_u32 s83, 0
  s_cbranch_scc1 L_loop
  s_sub_u32 s83, s83, 1
  s_waitcnt vmcnt(36)
  v_dot2_f32_bf16 v13, v64, v9, 0
  v_dot2_f32_bf16 v14, v68, v9, 0
  v_dot2_f32_bf16 v15, v72, v9, 0
  v_dot2_f32_bf16 v16, v76, v9, 0
  v_dot2_f32_bf16 v13, v65, v10, v13
  v_dot2_f32_bf16 v14, v69, v10, v14
  v_dot2_f32_bf16 v15, v73, v10, v15
  v_dot2_f32_bf16 v16, v77, v10, v16
  v_dot2_f32_bf16 v13, v66, v11, v13
  v_dot2_f32_bf16 v14, v70, v11, v14
  v_dot2_f32_bf16 v15, v74, v11, v15
  v_dot2_f32_bf16 v16, v78, v11, v16
  v_dot2_f32_bf16 v13, v67, v12, v13
  v_dot2_f32_bf16 v14, v71, v12, v14
  v_dot2_f32_bf16 v15, v75, v12, v15
  v_dot2_f32_bf16 v16, v79, v12, v16
  s_add_u32 s25, s65, s80
  s_and_b32 s25, s25, 511
  s_lshl_b32 s25, s25, 12
  s_add_u32 s25, s25, s66
  s_mov_b32 s68, s25
  s_add_u32 s65, s65, 1
  buffer_load_dwordx4 v[64:67], v2, s[8:11], s68 offen offset:0 nt
  buffer_load_dwordx4 v[68:71], v2, s[8:11], s68 offen offset:1024 nt
  buffer_load_dwordx4 v[72:75], v2, s[8:11], s68 offen offset:2048 nt
  buffer_load_dwordx4 v[76:79], v2, s[8:11], s68 offen offset:3072 nt
  v_add_f32_dpp v13, v13, v13 row_ror:8 row_mask:0xf bank_mask:0xf
  v_add_f32_dpp v14, v14, v14 row_ror:8 row_mask:0xf bank_mask:0xf
  v_add_f32_dpp v15, v15, v15 row_ror:8 row_mask:0xf bank_mask:0xf
  v_add_f32_dpp v16, v16, v16 row_ror:8 row_mask:0xf bank_mask:0xf
  v_add_f32_dpp v13, v13, v13 row_ror:4 row_mask:0xf bank_mask:0xf
  v_add_f32_dpp v14, v14, v14 row_ror:4 row_mask:0xf bank_mask:0xf
  v_add_f32_dpp v15, v15, v15 row_ror:4 row_mask:0xf bank_mask:0xf
  v_add_f32_dpp v16, v16, v16 row_ror:4 row_mask:0xf bank_mask:0xf
  v_add_f32_dpp v13, v13, v13 row_ror:2 row_mask:0xf bank_mask:0xf
  v_add_f32_dpp v14, v14, v14 row_ror:2 row_mask:0xf bank_mask:0xf
  v_add_f32_dpp v15, v15, v15 row_ror:2 row_mask:0xf bank_mask:0xf
  v_add_f32_dpp v16, v16, v16 row_ror:2 row_mask:0xf bank_mask:0xf
  v_add_f32_dpp v13, v13, v13 row_ror:1 row_mask:0xf bank_mask:0xf
  v_add_f32_dpp v14, v14, v14 row_ror:1 row_mask:0xf bank_mask:0xf
  v_add_f32_dpp v15, v15, v15 row_ror:1 row_mask:0xf bank_mask:0xf
  v_add_f32_dpp v16, v16, v16 row_ror:1 row_mask:0xf bank_mask:0xf
  v_cvt_pk_bf16_f32 v17, v13, v14
  v_cvt_pk_bf16_f32 v18, v15, v16
  v_lshlrev_b32 v13, 16, v17
  v_and_b32 v14, 0xffff0000, v17
  v_lshlrev_b32 v15, 16, v18
  v_and_b32 v16, 0xffff0000, v18
  v_mul_f32 v13, s26, v13
  v_mul_f32 v14, s26, v14
  v_mul_f32 v15, s26, v15
  v_mul_f32 v16, s26, v16
  v_cvt_pk_bf16_f32 v17, v13, v14
  v_cvt_pk_bf16_f32 v18, v15, v16
  v_lshlrev_b32 v13, 16, v17
  v_and_b32 v14, 0xffff0000, v17
  v_lshlrev_b32 v15, 16, v18
  v_and_b32 v16, 0xffff0000, v18
  v_max3_f32 v20, v13, v14, v19
  v_max3_f32 v20, v15, v16, v20
  v_mov_b32 v21, v20
  s_nop 1
  v_permlane16_swap_b32 v20, v21
  v_max_f32 v20, v20, v21
  v_mov_b32 v21, v20
  s_nop 1
  v_permlane32_swap_b32 v20, v21
  v_max_f32 v20, v20, v21
  v_sub_f32 v22, v19, v20
  v_mul_f32 v23, 0x3fb8aa3b, v20
  v_mul_f32 v22, 0x3fb8aa3b, v22
  v_mov_b32 v19, v20
  v_exp_f32 v22, v22
  v_mov_b32 v21, 0x3fb8aa3b
  v_fma_f32 v13, v13, v21, -v23
  v_fma_f32 v14, v14, v21, -v23
  v_fma_f32 v15, v15, v21, -v23
  v_fma_f32 v16, v16, v21, -v23
  v_exp_f32 v13, v13
  v_exp_f32 v14, v14
  v_exp_f32 v15, v15
  v_exp_f32 v16, v16
  v_mul_f32 v28, v22, v28
  v_mul_f32 v29, v22, v29
  v_mul_f32 v30, v22, v30
  v_mul_f32 v31, v22, v31
  v_cvt_pk_bf16_f32 v48, v13, v13
  v_cvt_pk_bf16_f32 v49, v14, v14
  v_cvt_pk_bf16_f32 v50, v15, v15
  v_cvt_pk_bf16_f32 v51, v16, v16
  v_add_f32 v17, v13, v14
  v_add_f32 v18, v15, v16
  v_and_b32 v32, v48, v5
  v_and_b32 v33, v48, v6
  v_and_b32 v34, v48, v7
  v_and_b32 v35, v48, v8
  v_and_b32 v36, v49, v5
  v_and_b32 v37, v49, v6
  v_and_b32 v38, v49, v7
  v_and_b32 v39, v49, v8
  v_and_b32 v40, v50, v5
  v_and_b32 v41, v50, v6
  v_and_b32 v42, v50, v7
  v_and_b32 v43, v50, v8
  v_and_b32 v44, v51, v5
  v_and_b32 v45, v51, v6
  v_and_b32 v46, v51, v7
  v_and_b32 v47, v51, v8
  v_add_f32 v17, v17, v18
  v_fma_f32 v24, v24, v22, v17
  s_waitcnt vmcnt(36)
  v_mfma_f32_16x16x32_bf16 v[28:31], v[80:83], v[32:35], v[28:31]
  v_mfma_f32_16x16x32_bf16 v[28:31], v[84:87], v[36:39], v[28:31]
  v_mfma_f32_16x16x32_bf16 v[28:31], v[88:91], v[40:43], v[28:31]
  v_mfma_f32_16x16x32_bf16 v[28:31], v[92:95], v[44:47], v[28:31]
  buffer_load_dwordx4 v[80:83], v2, s[12:15], s68 offen offset:0 nt
  buffer_load_dwordx4 v[84:87], v2, s[12:15], s68 offen offset:1024 nt
  buffer_load_dwordx4 v[88:91], v2, s[12:15], s68 offen offset:2048 nt
  buffer_load_dwordx4 v[92:95], v2, s[12:15], s68 offen offset:3072 nt
  s_waitcnt vmcnt(36)
  v_dot2_f32_bf16 v13, v96, v9, 0
  v_dot2_f32_bf16 v14, v100, v9, 0
  v_dot2_f32_bf16 v15, v104, v9, 0
  v_dot2_f32_bf16 v16, v108, v9, 0
  v_dot2_f32_bf16 v13, v97, v10, v13
  v_dot2_f32_bf16 v14, v101, v10, v14
  v_dot2_f32_bf16 v15, v105, v10, v15
  v_dot2_f32_bf16 v16, v109, v10, v16
  v_dot2_f32_bf16 v13, v98, v11, v13
  v_dot2_f32_bf16 v14, v102, v11, v14
  v_dot2_f32_bf16 v15, v106, v11, v15
  v_dot2_f32_bf16 v16, v110, v11, v16
  v_dot2_f32_bf16 v13, v99, v12, v13
  v_dot2_f32_bf16 v14, v103, v12, v14
  v_dot2_f32_bf16 v15, v107, v12, v15
  v_dot2_f32_bf16 v16, v111, v12, v16
  s_add_u32 s25, s65, s80
  s_and_b32 s25, s25, 511
  s_lshl_b32 s25, s25, 12
  s_add_u32 s25, s25, s66
  s_mov_b32 s69, s25
  s_add_u32 s65, s65, 1
  buffer_load_dwordx4 v[96:99], v2, s[8:11], s69 offen offset:0 nt
  buffer_load_dwordx4 v[100:103], v2, s[8:11], s69 offen offset:1024 nt
  buffer_load_dwordx4 v[104:107], v2, s[8:11], s69 offen offset:2048 nt
  buffer_load_dwordx4 v[108:111], v2, s[8:11], s69 offen offset:3072 nt
  v_add_f32_dpp v13, v13, v13 row_ror:8 row_mask:0xf bank_mask:0xf
  v_add_f32_dpp v14, v14, v14 row_ror:8 row_mask:0xf bank_mask:0xf
  v_add_f32_dpp v15, v15, v15 row_ror:8 row_mask:0xf bank_mask:0xf
  v_add_f32_dpp v16, v16, v16 row_ror:8 row_mask:0xf bank_mask:0xf
  v_add_f32_dpp v13, v13, v13 row_ror:4 row_mask:0xf bank_mask:0xf
  v_add_f32_dpp v14, v14, v14 row_ror:4 row_mask:0xf bank_mask:0xf
  v_add_f32_dpp v15, v15, v15 row_ror:4 row_mask:0xf bank_mask:0xf
  v_add_f32_dpp v16, v16, v16 row_ror:4 row_mask:0xf bank_mask:0xf
  v_add_f32_dpp v13, v13, v13 row_ror:2 row_mask:0xf bank_mask:0xf
  v_add_f32_dpp v14, v14, v14 row_ror:2 row_mask:0xf bank_mask:0xf
  v_add_f32_dpp v15, v15, v15 row_ror:2 row_mask:0xf bank_mask:0xf
  v_add_f32_dpp v16, v16, v16 row_ror:2 row_mask:0xf bank_mask:0xf
  v_add_f32_dpp v13, v13, v13 row_ror:1 row_mask:0xf bank_mask:0xf
  v_add_f32_dpp v14, v14, v14 row_ror:1 row_mask:0xf bank_mask:0xf
  v_add_f32_dpp v15, v15, v15 row_ror:1 row_mask:0xf bank_mask:0xf
  v_add_f32_dpp v16, v16, v16 row_ror:1 row_mask:0xf bank_mask:0xf
  v_cvt_pk_bf16_f32 v17, v13, v14
  v_cvt_pk_bf16_f32 v18, v15, v16
  v_lshlrev_b32 v13, 16, v17
  v_and_b32 v14, 0xffff0000, v17
  v_lshlrev_b32 v15, 16, v18
  v_and_b32 v16, 0xffff0000, v18
  v_mul_f32 v13, s26, v13
  v_mul_f32 v14, s26, v14
  v_mul_f32 v15, s26, v15
  v_mul_f32 v16, s26, v16
  v_cvt_pk_bf16_f32 v17, v13, v14
  v_cvt_pk_bf16_f32 v18, v15, v16
  v_lshlrev_b32 v13, 16, v17
  v_and_b32 v14, 0xffff0000, v17
  v_lshlrev_b32 v15, 16, v18
  v_and_b32 v16, 0xffff0000, v18
  v_max3_f32 v20, v13, v14, v19
  v_max3_f32 v20, v15, v16, v20
  v_mov_b32 v21, v20
  s_nop 1
  v_permlane16_swap_b32 v20, v21
  v_max_f32 v20, v20, v21
  v_mov_b32 v21, v20
  s_nop 1
  v_permlane32_swap_b32 v20, v21
  v_max_f32 v20, v20, v21
  v_sub_f32 v22, v19, v20
  v_mul_f32 v23, 0x3fb8aa3b, v20
  v_mul_f32 v22, 0x3fb8aa3b, v22
  v_mov_b32 v19, v20
  v_exp_f32 v22, v22
  v_mov_b32 v21, 0x3fb8aa3b
  v_fma_f32 v13, v13, v21, -v23
  v_fma_f32 v14, v14, v21, -v23
  v_fma_f32 v15, v15, v21, -v23
  v_fma_f32 v16, v16, v21, -v23
  v_exp_f32 v13, v13
  v_exp_f32 v14, v14
  v_exp_f32 v15, v15
  v_exp_f32 v16, v16
  v_mul_f32 v28, v22, v28
  v_mul_f32 v29, v22, v29
  v_mul_f32 v30, v22, v30
  v_mul_f32 v31, v22, v31
  v_cvt_pk_bf16_f32 v48, v13, v13
  v_cvt_pk_bf16_f32 v49, v14, v14
  v_cvt_pk_bf16_f32 v50, v15, v15
  v_cvt_pk_bf16_f32 v51, v16, v16
  v_add_f32 v17, v13, v14
  v_add_f32 v18, v15, v16
  v_and_b32 v32, v48, v5
  v_and_b32 v33, v48, v6
  v_and_b32 v34, v48, v7
  v_and_b32 v35, v48, v8
  v_and_b32 v36, v49, v5
  v_and_b32 v37, v49, v6
  v_and_b32 v38, v49, v7
  v_and_b32 v39, v49, v8
  v_and_b32 v40, v50, v5
  v_and_b32 v41, v50, v6
  v_and_b32 v42, v50, v7
  v_and_b32 v43, v50, v8
  v_and_b32 v44, v51, v5
  v_and_b32 v45, v51, v6
  v_and_b32 v46, v51, v7
  v_and_b32 v47, v51, v8
  v_add_f32 v17, v17, v18
  v_fma_f32 v24, v24, v22, v17
  s_waitcnt vmcnt(36)
  v_mfma_f32_16x16x32_bf16 v[28:31], v[112:115], v[32:35], v[28:31]
  v_mfma_f32_16x16x32_bf16 v[28:31], v[116:119], v[36:39], v[28:31]
  v_mfma_f32_16x16x32_bf16 v[28:31], v[120:123], v[40:43], v[28:31]
  v_mfma_f32_16x16x32_bf16 v[28:31], v[124:127], v[44:47], v[28:31]
  buffer_load_dwordx4 v[112:115], v2, s[12:15], s69 offen offset:0 nt
  buffer_load_dwordx4 v[116:119], v2, s[12:15], s69 offen offset:1024 nt
  buffer_load_dwordx4 v[120:123], v2, s[12:15], s69 offen offset:2048 nt
  buffer_load_dwordx4 v[124:127], v2, s[12:15], s69 offen offset:3072 nt
  s_waitcnt vmcnt(36)
  v_dot2_f32_bf16 v13, v128, v9, 0
  v_dot2_f32_bf16 v14, v132, v9, 0
  v_dot2_f32_bf16 v15, v136, v9, 0
  v_dot2_f32_bf16 v16, v140, v9, 0
  v_dot2_f32_bf16 v13, v129, v10, v13
  v_dot2_f32_bf16 v14, v133, v10, v14
  v_dot2_f32_bf16 v15, v137, v10, v15
  v_dot2_f32_bf16 v16, v141, v10, v16
  v_dot2_f32_bf16 v13, v130, v11, v13
  v_dot2_f32_bf16 v14, v134, v11, v14
  v_dot2_f32_bf16 v15, v138, v11, v15
  v_dot2_f32_bf16 v16, v142, v11, v16
  v_dot2_f32_bf16 v13, v131, v12, v13
  v_dot2_f32_bf16 v14, v135, v12, v14
  v_dot2_f32_bf16 v15, v139, v12, v15
  v_dot2_f32_bf16 v16, v143, v12, v16
  s_add_u32 s25, s65, s80
  s_and_b32 s25, s25, 511
  s_lshl_b32 s25, s25, 12
  s_add_u32 s25, s25, s66
  s_mov_b32 s70, s25
  s_add_u32 s65, s65, 1
  buffer_load_dwordx4 v[128:131], v2, s[8:11], s70 offen offset:0 nt
  buffer_load_dwordx4 v[132:135], v2, s[8:11], s70 offen offset:1024 nt
  buffer_load_dwordx4 v[136:139], v2, s[8:11], s70 offen offset:2048 nt
  buffer_load_dwordx4 v[140:143], v2, s[8:11], s70 offen offset:3072 nt
  v_add_f32_dpp v13, v13, v13 row_ror:8 row_mask:0xf bank_mask:0xf
  v_add_f32_dpp v14, v14, v14 row_ror:8 row_mask:0xf bank_mask:0xf
  v_add_f32_dpp v15, v15, v15 row_ror:8 row_mask:0xf bank_mask:0xf
  v_add_f32_dpp v16, v16, v16 row_ror:8 row_mask:0xf bank_mask:0xf
  v_add_f32_dpp v13, v13, v13 row_ror:4 row_mask:0xf bank_mask:0xf
  v_add_f32_dpp v14, v14, v14 row_ror:4 row_mask:0xf bank_mask:0xf
  v_add_f32_dpp v15, v15, v15 row_ror:4 row_mask:0xf bank_mask:0xf
  v_add_f32_dpp v16, v16, v16 row_ror:4 row_mask:0xf bank_mask:0xf
  v_add_f32_dpp v13, v13, v13 row_ror:2 row_mask:0xf bank_mask:0xf
  v_add_f32_dpp v14, v14, v14 row_ror:2 row_mask:0xf bank_mask:0xf
  v_add_f32_dpp v15, v15, v15 row_ror:2 row_mask:0xf bank_mask:0xf
  v_add_f32_dpp v16, v16, v16 row_ror:2 row_mask:0xf bank_mask:0xf
  v_add_f32_dpp v13, v13, v13 row_ror:1 row_mask:0xf bank_mask:0xf
  v_add_f32_dpp v14, v14, v14 row_ror:1 row_mask:0xf bank_mask:0xf
  v_add_f32_dpp v15, v15, v15 row_ror:1 row_mask:0xf bank_mask:0xf
  v_add_f32_dpp v16, v16, v16 row_ror:1 row_mask:0xf bank_mask:0xf
  v_cvt_pk_bf16_f32 v17, v13, v14
  v_cvt_pk_bf16_f32 v18, v15, v16
  v_lshlrev_b32 v13, 16, v17
  v_and_b32 v14, 0xffff0000, v17
  v_lshlrev_b32 v15, 16, v18
  v_and_b32 v16, 0xffff0000, v18
  v_mul_f32 v13, s26, v13
  v_mul_f32 v14, s26, v14
  v_mul_f32 v15, s26, v15
  v_mul_f32 v16, s26, v16
  v_cvt_pk_bf16_f32 v17, v13, v14
  v_cvt_pk_bf16_f32 v18, v15, v16
  v_lshlrev_b32 v13, 16, v17
  v_and_b32 v14, 0xffff0000, v17
  v_lshlrev_b32 v15, 16, v18
  v_and_b32 v16, 0xffff0000, v18
  v_max3_f32 v20, v13, v14, v19
  v_max3_f32 v20, v15, v16, v20
  v_mov_b32 v21, v20
  s_nop 1
  v_permlane16_swap_b32 v20, v21
  v_max_f32 v20, v20, v21
  v_mov_b32 v21, v20
  s_nop 1
  v_permlane32_swap_b32 v20, v21
  v_max_f32 v20, v20, v21
  v_sub_f32 v22, v19, v20
  v_mul_f32 v23, 0x3fb8aa3b, v20
  v_mul_f32 v22, 0x3fb8aa3b, v22
  v_mov_b32 v19, v20
  v_exp_f32 v22, v22
  v_mov_b32 v21, 0x3fb8aa3b
  v_fma_f32 v13, v13, v21, -v23
  v_fma_f32 v14, v14, v21, -v23
  v_fma_f32 v15, v15, v21, -v23
  v_fma_f32 v16, v16, v21, -v23
  v_exp_f32 v13, v13
  v_exp_f32 v14, v14
  v_exp_f32 v15, v15
  v_exp_f32 v16, v16
  v_mul_f32 v28, v22, v28
  v_mul_f32 v29, v22, v29
  v_mul_f32 v30, v22, v30
  v_mul_f32 v31, v22, v31
  v_cvt_pk_bf16_f32 v48, v13, v13
  v_cvt_pk_bf16_f32 v49, v14, v14
  v_cvt_pk_bf16_f32 v50, v15, v15
  v_cvt_pk_bf16_f32 v51, v16, v16
  v_add_f32 v17, v13, v14
  v_add_f32 v18, v15, v16
  v_and_b32 v32, v48, v5
  v_and_b32 v33, v48, v6
  v_and_b32 v34, v48, v7
  v_and_b32 v35, v48, v8
  v_and_b32 v36, v49, v5
  v_and_b32 v37, v49, v6
  v_and_b32 v38, v49, v7
  v_and_b32 v39, v49, v8
  v_and_b32 v40, v50, v5
  v_and_b32 v41, v50, v6
  v_and_b32 v42, v50, v7
  v_and_b32 v43, v50, v8
  v_and_b32 v44, v51, v5
  v_and_b32 v45, v51, v6
  v_and_b32 v46, v51, v7
  v_and_b32 v47, v51, v8
  v_add_f32 v17, v17, v18
  v_fma_f32 v24, v24, v22, v17
  s_waitcnt vmcnt(36)
  v_mfma_f32_16x16x32_bf16 v[28:31], v[144:147], v[32:35], v[28:31]
  v_mfma_f32_16x16x32_bf16 v[28:31], v[148:151], v[36:39], v[28:31]
  v_mfma_f32_16x16x32_bf16 v[28:31], v[152:155], v[40:43], v[28:31]
  v_mfma_f32_16x16x32_bf16 v[28:31], v[156:159], v[44:47], v[28:31]
  buffer_load_dwordx4 v[144:147], v2, s[12:15], s70 offen offset:0 nt
  buffer_load_dwordx4 v[148:151], v2, s[12:15], s70 offen offset:1024 nt
  buffer_load_dwordx4 v[152:155], v2, s[12:15], s70 offen offset:2048 nt
  buffer_load_dwordx4 v[156:159], v2, s[12:15], s70 offen offset:3072 nt
  s_waitcnt vmcnt(36)
  v_dot2_f32_bf16 v13, v160, v9, 0
  v_dot2_f32_bf16 v14, v164, v9, 0
  v_dot2_f32_bf16 v15, v168, v9, 0
  v_dot2_f32_bf16 v16, v172, v9, 0
  v_dot2_f32_bf16 v13, v161, v10, v13
  v_dot2_f32_bf16 v14, v165, v10, v14
  v_dot2_f32_bf16 v15, v169, v10, v15
  v_dot2_f32_bf16 v16, v173, v10, v16
  v_dot2_f32_bf16 v13, v162, v11, v13
  v_dot2_f32_bf16 v14, v166, v11, v14
  v_dot2_f32_bf16 v15, v170, v11, v15
  v_dot2_f32_bf16 v16, v174, v11, v16
  v_dot2_f32_bf16 v13, v163, v12, v13
  v_dot2_f32_bf16 v14, v167, v12, v14
  v_dot2_f32_bf16 v15, v171, v12, v15
  v_dot2_f32_bf16 v16, v175, v12, v16
  s_add_u32 s25, s65, s80
  s_and_b32 s25, s25, 511
  s_lshl_b32 s25, s25, 12
  s_add_u32 s25, s25, s66
  s_mov_b32 s71, s25
  s_add_u32 s65, s65, 1
  buffer_load_dwordx4 v[160:163], v2, s[8:11], s71 offen offset:0 nt
  buffer_load_dwordx4 v[164:167], v2, s[8:11], s71 offen offset:1024 nt
  buffer_load_dwordx4 v[168:171], v2, s[8:11], s71 offen offset:2048 nt
  buffer_load_dwordx4 v[172:175], v2, s[8:11], s71 offen offset:3072 nt
  v_add_f32_dpp v13, v13, v13 row_ror:8 row_mask:0xf bank_mask:0xf
  v_add_f32_dpp v14, v14, v14 row_ror:8 row_mask:0xf bank_mask:0xf
  v_add_f32_dpp v15, v15, v15 row_ror:8 row_mask:0xf bank_mask:0xf
  v_add_f32_dpp v16, v16, v16 row_ror:8 row_mask:0xf bank_mask:0xf
  v_add_f32_dpp v13, v13, v13 row_ror:4 row_mask:0xf bank_mask:0xf
  v_add_f32_dpp v14, v14, v14 row_ror:4 row_mask:0xf bank_mask:0xf
  v_add_f32_dpp v15, v15, v15 row_ror:4 row_mask:0xf bank_mask:0xf
  v_add_f32_dpp v16, v16, v16 row_ror:4 row_mask:0xf bank_mask:0xf
  v_add_f32_dpp v13, v13, v13 row_ror:2 row_mask:0xf bank_mask:0xf
  v_add_f32_dpp v14, v14, v14 row_ror:2 row_mask:0xf bank_mask:0xf
  v_add_f32_dpp v15, v15, v15 row_ror:2 row_mask:0xf bank_mask:0xf
  v_add_f32_dpp v16, v16, v16 row_ror:2 row_mask:0xf bank_mask:0xf
  v_add_f32_dpp v13, v13, v13 row_ror:1 row_mask:0xf bank_mask:0xf
  v_add_f32_dpp v14, v14, v14 row_ror:1 row_mask:0xf bank_mask:0xf
  v_add_f32_dpp v15, v15, v15 row_ror:1 row_mask:0xf bank_mask:0xf
  v_add_f32_dpp v16, v16, v16 row_ror:1 row_mask:0xf bank_mask:0xf
  v_cvt_pk_bf16_f32 v17, v13, v14
  v_cvt_pk_bf16_f32 v18, v15, v16
  v_lshlrev_b32 v13, 16, v17
  v_and_b32 v14, 0xffff0000, v17
  v_lshlrev_b32 v15, 16, v18
  v_and_b32 v16, 0xffff0000, v18
  v_mul_f32 v13, s26, v13
  v_mul_f32 v14, s26, v14
  v_mul_f32 v15, s26, v15
  v_mul_f32 v16, s26, v16
  v_cvt_pk_bf16_f32 v17, v13, v14
  v_cvt_pk_bf16_f32 v18, v15, v16
  v_lshlrev_b32 v13, 16, v17
  v_and_b32 v14, 0xffff0000, v17
  v_lshlrev_b32 v15, 16, v18
  v_and_b32 v16, 0xffff0000, v18
  v_max3_f32 v20, v13, v14, v19
  v_max3_f32 v20, v15, v16, v20
  v_mov_b32 v21, v20
  s_nop 1
  v_permlane16_swap_b32 v20, v21
  v_max_f32 v20, v20, v21
  v_mov_b32 v21, v20
  s_nop 1
  v_permlane32_swap_b32 v20, v21
  v_max_f32 v20, v20, v21
  v_sub_f32 v22, v19, v20
  v_mul_f32 v23, 0x3fb8aa3b, v20
  v_mul_f32 v22, 0x3fb8aa3b, v22
  v_mov_b32 v19, v20
  v_exp_f32 v22, v22
  v_mov_b32 v21, 0x3fb8aa3b
  v_fma_f32 v13, v13, v21, -v23
  v_fma_f32 v14, v14, v21, -v23
  v_fma_f32 v15, v15, v21, -v23
  v_fma_f32 v16, v16, v21, -v23
  v_exp_f32 v13, v13
  v_exp_f32 v14, v14
  v_exp_f32 v15, v15
  v_exp_f32 v16, v16
  v_mul_f32 v28, v22, v28
  v_mul_f32 v29, v22, v29
  v_mul_f32 v30, v22, v30
  v_mul_f32 v31, v22, v31
  v_cvt_pk_bf16_f32 v48, v13, v13
  v_cvt_pk_bf16_f32 v49, v14, v14
  v_cvt_pk_bf16_f32 v50, v15, v15
  v_cvt_pk_bf16_f32 v51, v16, v16
  v_add_f32 v17, v13, v14
  v_add_f32 v18, v15, v16
  v_and_b32 v32, v48, v5
  v_and_b32 v33, v48, v6
  v_and_b32 v34, v48, v7
  v_and_b32 v35, v48, v8
  v_and_b32 v36, v49, v5
  v_and_b32 v37, v49, v6
  v_and_b32 v38, v49, v7
  v_and_b32 v39, v49, v8
  v_and_b32 v40, v50, v5
  v_and_b32 v41, v50, v6
  v_and_b32 v42, v50, v7
  v_and_b32 v43, v50, v8
  v_and_b32 v44, v51, v5
  v_and_b32 v45, v51, v6
  v_and_b32 v46, v51, v7
  v_and_b32 v47, v51, v8
  v_add_f32 v17, v17, v18
  v_fma_f32 v24, v24, v22, v17
  s_waitcnt vmcnt(36)
  v_mfma_f32_16x16x32_bf16 v[28:31], v[176:179], v[32:35], v[28:31]
  v_mfma_f32_16x16x32_bf16 v[28:31], v[180:183], v[36:39], v[28:31]
  v_mfma_f32_16x16x32_bf16 v[28:31], v[184:187], v[40:43], v[28:31]
  v_mfma_f32_16x16x32_bf16 v[28:31], v[188:191], v[44:47], v[28:31]
  buffer_load_dwordx4 v[176:179], v2, s[12:15], s71 offen offset:0 nt
  buffer_load_dwordx4 v[180:183], v2, s[12:15], s71 offen offset:1024 nt
  buffer_load_dwordx4 v[184:187], v2, s[12:15], s71 offen offset:2048 nt
  buffer_load_dwordx4 v[188:191], v2, s[12:15], s71 offen offset:3072 nt
  s_waitcnt vmcnt(36)
  v_dot2_f32_bf16 v13, v192, v9, 0
  v_dot2_f32_bf16 v14, v196, v9, 0
  v_dot2_f32_bf16 v15, v200, v9, 0
  v_dot2_f32_bf16 v16, v204, v9, 0
  v_dot2_f32_bf16 v13, v193, v10, v13
  v_dot2_f32_bf16 v14, v197, v10, v14
  v_dot2_f32_bf16 v15, v201, v10, v15
  v_dot2_f32_bf16 v16, v205, v10, v16
  v_dot2_f32_bf16 v13, v194, v11, v13
  v_dot2_f32_bf16 v14, v198, v11, v14
  v_dot2_f32_bf16 v15, v202, v11, v15
  v_dot2_f32_bf16 v16, v206, v11, v16
  v_dot2_f32_bf16 v13, v195, v12, v13
  v_dot2_f32_bf16 v14, v199, v12, v14
  v_dot2_f32_bf16 v15, v203, v12, v15
  v_dot2_f32_bf16 v16, v207, v12, v16
  s_add_u32 s25, s65, s80
  s_and_b32 s25, s25, 511
  s_lshl_b32 s25, s25, 12
  s_add_u32 s25, s25, s66
  s_mov_b32 s72, s25
  s_add_u32 s65, s65, s82
  buffer_load_dwordx4 v[192:195], v2, s[8:11], s72 offen offset:0 nt
  buffer_load_dwordx4 v[196:199], v2, s[8:11], s72 offen offset:1024 nt
  buffer_load_dwordx4 v[200:203], v2, s[8:11], s72 offen offset:2048 nt
  buffer_load_dwordx4 v[204:207], v2, s[8:11], s72 offen offset:3072 nt
  v_add_f32_dpp v13, v13, v13 row_ror:8 row_mask:0xf bank_mask:0xf
  v_add_f32_dpp v14, v14, v14 row_ror:8 row_mask:0xf bank_mask:0xf
  v_add_f32_dpp v15, v15, v15 row_ror:8 row_mask:0xf bank_mask:0xf
  v_add_f32_dpp v16, v16, v16 row_ror:8 row_mask:0xf bank_mask:0xf
  v_add_f32_dpp v13, v13, v13 row_ror:4 row_mask:0xf bank_mask:0xf
  v_add_f32_dpp v14, v14, v14 row_ror:4 row_mask:0xf bank_mask:0xf
  v_add_f32_dpp v15, v15, v15 row_ror:4 row_mask:0xf bank_mask:0xf
  v_add_f32_dpp v16, v16, v16 row_ror:4 row_mask:0xf bank_mask:0xf
  v_add_f32_dpp v13, v13, v13 row_ror:2 row_mask:0xf bank_mask:0xf
  v_add_f32_dpp v14, v14, v14 row_ror:2 row_mask:0xf bank_mask:0xf
  v_add_f32_dpp v15, v15, v15 row_ror:2 row_mask:0xf bank_mask:0xf
  v_add_f32_dpp v16, v16, v16 row_ror:2 row_mask:0xf bank_mask:0xf
  v_add_f32_dpp v13, v13, v13 row_ror:1 row_mask:0xf bank_mask:0xf
  v_add_f32_dpp v14, v14, v14 row_ror:1 row_mask:0xf bank_mask:0xf
  v_add_f32_dpp v15, v15, v15 row_ror:1 row_mask:0xf bank_mask:0xf
  v_add_f32_dpp v16, v16, v16 row_ror:1 row_mask:0xf bank_mask:0xf
  v_cvt_pk_bf16_f32 v17, v13, v14
  v_cvt_pk_bf16_f32 v18, v15, v16
  v_lshlrev_b32 v13, 16, v17
  v_and_b32 v14, 0xffff0000, v17
  v_lshlrev_b32 v15, 16, v18
  v_and_b32 v16, 0xffff0000, v18
  v_mul_f32 v13, s26, v13
  v_mul_f32 v14, s26, v14
  v_mul_f32 v15, s26, v15
  v_mul_f32 v16, s26, v16
  v_cvt_pk_bf16_f32 v17, v13, v14
  v_cvt_pk_bf16_f32 v18, v15, v16
  v_lshlrev_b32 v13, 16, v17
  v_and_b32 v14, 0xffff0000, v17
  v_lshlrev_b32 v15, 16, v18
  v_and_b32 v16, 0xffff0000, v18
  v_max3_f32 v20, v13, v14, v19
  v_max3_f32 v20, v15, v16, v20
  v_mov_b32 v21, v20
  s_nop 1
  v_permlane16_swap_b32 v20, v21
  v_max_f32 v20, v20, v21
  v_mov_b32 v21, v20
  s_nop 1
  v_permlane32_swap_b32 v20, v21
  v_max_f32 v20, v20, v21
  v_sub_f32 v22, v19, v20
  v_mul_f32 v23, 0x3fb8aa3b, v20
  v_mul_f32 v22, 0x3fb8aa3b, v22
  v_mov_b32 v19, v20
  v_exp_f32 v22, v22
  v_mov_b32 v21, 0x3fb8aa3b
  v_fma_f32 v13, v13, v21, -v23
  v_fma_f32 v14, v14, v21, -v23
  v_fma_f32 v15, v15, v21, -v23
  v_fma_f32 v16, v16, v21, -v23
  v_exp_f32 v13, v13
  v_exp_f32 v14, v14
  v_exp_f32 v15, v15
  v_exp_f32 v16, v16
  v_mul_f32 v28, v22, v28
  v_mul_f32 v29, v22, v29
  v_mul_f32 v30, v22, v30
  v_mul_f32 v31, v22, v31
  v_cvt_pk_bf16_f32 v48, v13, v13
  v_cvt_pk_bf16_f32 v49, v14, v14
  v_cvt_pk_bf16_f32 v50, v15, v15
  v_cvt_pk_bf16_f32 v51, v16, v16
  v_add_f32 v17, v13, v14
  v_add_f32 v18, v15, v16
  v_and_b32 v32, v48, v5
  v_and_b32 v33, v48, v6
  v_and_b32 v34, v48, v7
  v_and_b32 v35, v48, v8
  v_and_b32 v36, v49, v5
  v_and_b32 v37, v49, v6
  v_and_b32 v38, v49, v7
  v_and_b32 v39, v49, v8
  v_and_b32 v40, v50, v5
  v_and_b32 v41, v50, v6
  v_and_b32 v42, v50, v7
  v_and_b32 v43, v50, v8
  v_and_b32 v44, v51, v5
  v_and_b32 v45, v51, v6
  v_and_b32 v46, v51, v7
  v_and_b32 v47, v51, v8
  v_add_f32 v17, v17, v18
  v_fma_f32 v24, v24, v22, v17
  s_waitcnt vmcnt(36)
  v_mfma_f32_16x16x32_bf16 v[28:31], v[208:211], v[32:35], v[28:31]
  v_mfma_f32_16x16x32_bf16 v[28:31], v[212:215], v[36:39], v[28:31]
  v_mfma_f32_16x16x32_bf16 v[28:31], v[216:219], v[40:43], v[28:31]
  v_mfma_f32_16x16x32_bf16 v[28:31], v[220:223], v[44:47], v[28:31]
  buffer_load_dwordx4 v[208:211], v2, s[12:15], s72 offen offset:0 nt
  buffer_load_dwordx4 v[212:215], v2, s[12:15], s72 offen offset:1024 nt
  buffer_load_dwordx4 v[216:219], v2, s[12:15], s72 offen offset:2048 nt
  buffer_load_dwordx4 v[220:223], v2, s[12:15], s72 offen offset:3072 nt
  s_branch L_loopa
L_loop:
  s_cmp_ge_u32 s68, 0x8000000
  s_cbranch_scc1 L_sdone
  s_waitcnt vmcnt(36)
  v_dot2_f32_bf16 v13, v64, v9, 0
  v_dot2_f32_bf16 v14, v68, v9, 0
  v_dot2_f32_bf16 v15, v72, v9, 0
  v_dot2_f32_bf16 v16, v76, v9, 0
  v_dot2_f32_bf16 v13, v65, v10, v13
  v_dot2_f32_bf16 v14, v69, v10, v14
  v_dot2_f32_bf16 v15, v73, v10, v15
  v_dot2_f32_bf16 v16, v77, v10, v16
  v_dot2_f32_bf16 v13, v66, v11, v13
  v_dot2_f32_bf16 v14, v70, v11, v14
  v_dot2_f32_bf16 v15, v74, v11, v15
  v_dot2_f32_bf16 v16, v78, v11, v16
  v_dot2_f32_bf16 v13, v67, v12, v13
  v_dot2_f32_bf16 v14, v71, v12, v14
  v_dot2_f32_bf16 v15, v75, v12, v15
  v_dot2_f32_bf16 v16, v79, v12, v16
  v_readfirstlane_b32 s24, v52
  s_mov_b64 exec, 1
  s_or_b32 s24, s24, s74
  s_cmp_ge_u32 s24, s64
  s_cselect_b32 s74, 512, 0
  s_cselect_b32 s25, 0, 1
  v_mov_b32 v52, s25
  s_add_u32 s25, s24, s80
  s_and_b32 s25, s25, 511
  s_lshl_b32 s25, s25, 12
  s_add_u32 s25, s25, s66
  s_cmp_lt_u32 s24, 512
  s_cselect_b32 s68, s25, 0x8000000
  buffer_atomic_add v52, off, s[16:19], s84 sc0 sc1
  s_mov_b64 exec, -1
  buffer_load_dwordx4 v[64:67], v2, s[8:11], s68 offen offset:0 nt
  buffer_load_dwordx4 v[68:71], v2, s[8:11], s68 offen offset:1024 nt
  buffer_load_dwordx4 v[72:75], v2, s[8:11], s68 offen offset:2048 nt
  buffer_load_dwordx4 v[76:79], v2, s[8:11], s68 offen offset:3072 nt
  v_add_f32_dpp v13, v13, v13 row_ror:8 row_mask:0xf bank_mask:0xf
  v_add_f32_dpp v14, v14, v14 row_ror:8 row_mask:0xf bank_mask:0xf
  v_add_f32_dpp v15, v15, v15 row_ror:8 row_mask:0xf bank_mask:0xf
  v_add_f32_dpp v16, v16, v16 row_ror:8 row_mask:0xf bank_mask:0xf
  v_add_f32_dpp v13, v13, v13 row_ror:4 row_mask:0xf bank_mask:0xf
  v_add_f32_dpp v14, v14, v14 row_ror:4 row_mask:0xf bank_mask:0xf
  v_add_f32_dpp v15, v15, v15 row_ror:4 row_mask:0xf bank_mask:0xf
  v_add_f32_dpp v16, v16, v16 row_ror:4 row_mask:0xf bank_mask:0xf
  v_add_f32_dpp v13, v13, v13 row_ror:2 row_mask:0xf bank_mask:0xf
  v_add_f32_dpp v14, v14, v14 row_ror:2 row_mask:0xf bank_mask:0xf
  v_add_f32_dpp v15, v15, v15 row_ror:2 row_mask:0xf bank_mask:0xf
  v_add_f32_dpp v16, v16, v16 row_ror:2 row_mask:0xf bank_mask:0xf
  v_add_f32_dpp v13, v13, v13 row_ror:1 row_mask:0xf bank_mask:0xf
  v_add_f32_dpp v14, v14, v14 row_ror:1 row_mask:0xf bank_mask:0xf
  v_add_f32_dpp v15, v15, v15 row_ror:1 row_mask:0xf bank_mask:0xf
  v_add_f32_dpp v16, v16, v16 row_ror:1 row_mask:0xf bank_mask:0xf
  v_cvt_pk_bf16_f32 v17, v13, v14
  v_cvt_pk_bf16_f32 v18, v15, v16
  v_lshlrev_b32 v13, 16, v17
  v_and_b32 v14, 0xffff0000, v17
  v_lshlrev_b32 v15, 16, v18
  v_and_b32 v16, 0xffff0000, v18
  v_mul_f32 v13, s26, v13
  v_mul_f32 v14, s26, v14
  v_mul_f32 v15, s26, v15
  v_mul_f32 v16, s26, v16
  v_cvt_pk_bf16_f32 v17, v13, v14
  v_cvt_pk_bf16_f32 v18, v15, v16
  v_lshlrev_b32 v13, 16, v17
  v_and_b32 v14, 0xffff0000, v17
  v_lshlrev_b32 v15, 16, v18
  v_and_b32 v16, 0xffff0000, v18
  v_max3_f32 v20, v13, v14, v19
  v_max3_f32 v20, v15, v16, v20
  v_mov_b32 v21, v20
  s_nop 1
  v_permlane16_swap_b32 v20, v21
  v_max_f32 v20, v20, v21
  v_mov_b32 v21, v20
  s_nop 1
  v_permlane32_swap_b32 v20, v21
  v_max_f32 v20, v20, v21
  v_sub_f32 v22, v19, v20
  v_mul_f32 v23, 0x3fb8aa3b, v20
  v_mul_f32 v22, 0x3fb8aa3b, v22
  v_mov_b32 v19, v20
  v_exp_f32 v22, v22
  v_mov_b32 v21, 0x3fb8aa3b
  v_fma_f32 v13, v13, v21, -v23
  v_fma_f32 v14, v14, v21, -v23
  v_fma_f32 v15, v15, v21, -v23
  v_fma_f32 v16, v16, v21, -v23
  v_exp_f32 v13, v13
  v_exp_f32 v14, v14
  v_exp_f32 v15, v15
  v_exp_f32 v16, v16
  v_mul_f32 v28, v22, v28
  v_mul_f32 v29, v22, v29
  v_mul_f32 v30, v22, v30
  v_mul_f32 v31, v22, v31
  v_cvt_pk_bf16_f32 v48, v13, v13
  v_cvt_pk_bf16_f32 v49, v14, v14
  v_cvt_pk_bf16_f32 v50, v15, v15
  v_cvt_pk_bf16_f32 v51, v16, v16
  v_add_f32 v17, v13, v14
  v_add_f32 v18, v15, v16
  v_and_b32 v32, v48, v5
  v_and_b32 v33, v48, v6
  v_and_b32 v34, v48, v7
  v_and_b32 v35, v48, v8
  v_and_b32 v36, v49, v5
  v_and_b32 v37, v49, v6
  v_and_b32 v38, v49, v7
  v_and_b32 v39, v49, v8
  v_and_b32 v40, v50, v5
  v_and_b32 v41, v50, v6
  v_and_b32 v42, v50, v7
  v_and_b32 v43, v50, v8
  v_and_b32 v44, v51, v5
  v_and_b32 v45, v51, v6
  v_and_b32 v46, v51, v7
  v_and_b32 v47, v51, v8
  v_add_f32 v17, v17, v18
  v_fma_f32 v24, v24, v22, v17
  s_waitcnt vmcnt(37)
  v_mfma_f32_16x16x32_bf16 v[28:31], v[80:83], v[32:35], v[28:31]
  v_mfma_f32_16x16x32_bf16 v[28:31], v[84:87], v[36:39], v[28:31]
  v_mfma_f32_16x16x32_bf16 v[28:31], v[88:91], v[40:43], v[28:31]
  v_mfma_f32_16x16x32_bf16 v[28:31], v[92:95], v[44:47], v[28:31]
  buffer_load_dwordx4 v[80:83], v2, s[12:15], s68 offen offset:0 nt
  buffer_load_dwordx4 v[84:87], v2, s[12:15], s68 offen offset:1024 nt
  buffer_load_dwordx4 v[88:91], v2, s[12:15], s68 offen offset:2048 nt
  buffer_load_dwordx4 v[92:95], v2, s[12:15], s68 offen offset:3072 nt
  s_cmp_ge_u32 s69, 0x8000000
  s_cbranch_scc1 L_sdone
  s_waitcnt vmcnt(36)
  v_dot2_f32_bf16 v13, v96, v9, 0
  v_dot2_f32_bf16 v14, v100, v9, 0
  v_dot2_f32_bf16 v15, v104, v9, 0
  v_dot2_f32_bf16 v16, v108, v9, 0
  v_dot2_f32_bf16 v13, v97, v10, v13
  v_dot2_f32_bf16 v14, v101, v10, v14
  v_dot2_f32_bf16 v15, v105, v10, v15
  v_dot2_f32_bf16 v16, v109, v10, v16
  v_dot2_f32_bf16 v13, v98, v11, v13
  v_dot2_f32_bf16 v14, v102, v11, v14
  v_dot2_f32_bf16 v15, v106, v11, v15
  v_dot2_f32_bf16 v16, v110, v11, v16
  v_dot2_f32_bf16 v13, v99, v12, v13
  v_dot2_f32_bf16 v14, v103, v12, v14
  v_dot2_f32_bf16 v15, v107, v12, v15
  v_dot2_f32_bf16 v16, v111, v12, v16
  v_readfirstlane_b32 s24, v53
  s_mov_b64 exec, 1
  s_or_b32 s24, s24, s75
  s_cmp_ge_u32 s24, s64
  s_cselect_b32 s75, 512, 0
  s_cselect_b32 s25, 0, 1
  v_mov_b32 v53, s25
  s_add_u32 s25, s24, s80
  s_and_b32 s25, s25, 511
  s_lshl_b32 s25, s25, 12
  s_add_u32 s25, s25, s66
  s_cmp_lt_u32 s24, 512
  s_cselect_b32 s69, s25, 0x8000000
  buffer_atomic_add v53, off, s[16:19], s84 sc0 sc1
  s_mov_b64 exec, -1
  buffer_load_dwordx4 v[96:99], v2, s[8:11], s69 offen offset:0 nt
  buffer_load_dwordx4 v[100:103], v2, s[8:11], s69 offen offset:1024 nt
  buffer_load_dwordx4 v[104:107], v2, s[8:11], s69 offen offset:2048 nt
  buffer_load_dwordx4 v[108:111], v2, s[8:11], s69 offen offset:3072 nt
  v_add_f32_dpp v13, v13, v13 row_ror:8 row_mask:0xf bank_mask:0xf
  v_add_f32_dpp v14, v14, v14 row_ror:8 row_mask:0xf bank_mask:0xf
  v_add_f32_dpp v15, v15, v15 row_ror:8 row_mask:0xf bank_mask:0xf
  v_add_f32_dpp v16, v16, v16 row_ror:8 row_mask:0xf bank_mask:0xf
  v_add_f32_dpp v13, v13, v13 row_ror:4 row_mask:0xf bank_mask:0xf
  v_add_f32_dpp v14, v14, v14 row_ror:4 row_mask:0xf bank_mask:0xf
  v_add_f32_dpp v15, v15, v15 row_ror:4 row_mask:0xf bank_mask:0xf
  v_add_f32_dpp v16, v16, v16 row_ror:4 row_mask:0xf bank_mask:0xf
  v_add_f32_dpp v13, v13, v13 row_ror:2 row_mask:0xf bank_mask:0xf
  v_add_f32_dpp v14, v14, v14 row_ror:2 row_mask:0xf bank_mask:0xf
  v_add_f32_dpp v15, v15, v15 row_ror:2 row_mask:0xf bank_mask:0xf
  v_add_f32_dpp v16, v16, v16 row_ror:2 row_mask:0xf bank_mask:0xf
  v_add_f32_dpp v13, v13, v13 row_ror:1 row_mask:0xf bank_mask:0xf
  v_add_f32_dpp v14, v14, v14 row_ror:1 row_mask:0xf bank_mask:0xf
  v_add_f32_dpp v15, v15, v15 row_ror:1 row_mask:0xf bank_mask:0xf
  v_add_f32_dpp v16, v16, v16 row_ror:1 row_mask:0xf bank_mask:0xf
  v_cvt_pk_bf16_f32 v17, v13, v14
  v_cvt_pk_bf16_f32 v18, v15, v16
  v_lshlrev_b32 v13, 16, v17
  v_and_b32 v14, 0xffff0000, v17
  v_lshlrev_b32 v15, 16, v18
  v_and_b32 v16, 0xffff0000, v18
  v_mul_f32 v13, s26, v13
  v_mul_f32 v14, s26, v14
  v_mul_f32 v15, s26, v15
  v_mul_f32 v16, s26, v16
  v_cvt_pk_bf16_f32 v17, v13, v14
  v_cvt_pk_bf16_f32 v18, v15, v16
  v_lshlrev_b32 v13, 16, v17
  v_and_b32 v14, 0xffff0000, v17
  v_lshlrev_b32 v15, 16, v18
  v_and_b32 v16, 0xffff0000, v18
  v_max3_f32 v20, v13, v14, v19
  v_max3_f32 v20, v15, v16, v20
  v_mov_b32 v21, v20
  s_nop 1
  v_permlane16_swap_b32 v20, v21
  v_max_f32 v20, v20, v21
  v_mov_b32 v21, v20
  s_nop 1
  v_permlane32_swap_b32 v20, v21
  v_max_f32 v20, v20, v21
  v_sub_f32 v22, v19, v20
  v_mul_f32 v23, 0x3fb8aa3b, v20
  v_mul_f32 v22, 0x3fb8aa3b, v22
  v_mov_b32 v19, v20
  v_exp_f32 v22, v22
  v_mov_b32 v21, 0x3fb8aa3b
  v_fma_f32 v13, v13, v21, -v23
  v_fma_f32 v14, v14, v21, -v23
  v_fma_f32 v15, v15, v21, -v23
  v_fma_f32 v16, v16, v21, -v23
  v_exp_f32 v13, v13
  v_exp_f32 v14, v14
  v_exp_f32 v15, v15
  v_exp_f32 v16, v16
  v_mul_f32 v28, v22, v28
  v_mul_f32 v29, v22, v29
  v_mul_f32 v30, v22, v30
  v_mul_f32 v31, v22, v31
  v_cvt_pk_bf16_f32 v48, v13, v13
  v_cvt_pk_bf16_f32 v49, v14, v14
  v_cvt_pk_bf16_f32 v50, v15, v15
  v_cvt_pk_bf16_f32 v51, v16, v16
  v_add_f32 v17, v13, v14
  v_add_f32 v18, v15, v16
  v_and_b32 v32, v48, v5
  v_and_b32 v33, v48, v6
  v_and_b32 v34, v48, v7
  v_and_b32 v35, v48, v8
  v_and_b32 v36, v49, v5
  v_and_b32 v37, v49, v6
  v_and_b32 v38, v49, v7
  v_and_b32 v39, v49, v8
  v_and_b32 v40, v50, v5
  v_and_b32 v41, v50, v6
  v_and_b32 v42, v50, v7
  v_and_b32 v43, v50, v8
  v_and_b32 v44, v51, v5
  v_and_b32 v45, v51, v6
  v_and_b32 v46, v51, v7
  v_and_b32 v47, v51, v8
  v_add_f32 v17, v17, v18
  v_fma_f32 v24, v24, v22, v17
  s_waitcnt vmcnt(37)
  v_mfma_f32_16x16x32_bf16 v[28:31], v[112:115], v[32:35], v[28:31]
  v_mfma_f32_16x16x32_bf16 v[28:31], v[116:119], v[36:39], v[28:31]
  v_mfma_f32_16x16x32_bf16 v[28:31], v[120:123], v[40:43], v[28:31]
  v_mfma_f32_16x16x32_bf16 v[28:31], v[124:127], v[44:47], v[28:31]
  buffer_load_dwordx4 v[112:115], v2, s[12:15], s69 offen offset:0 nt
  buffer_load_dwordx4 v[116:119], v2, s[12:15], s69 offen offset:1024 nt
  buffer_load_dwordx4 v[120:123], v2, s[12:15], s69 offen offset:2048 nt
  buffer_load_dwordx4 v[124:127], v2, s[12:15], s69 offen offset:3072 nt
  s_cmp_ge_u32 s70, 0x8000000
  s_cbranch_scc1 L_sdone
  s_waitcnt vmcnt(36)
  v_dot2_f32_bf16 v13, v128, v9, 0
  v_dot2_f32_bf16 v14, v132, v9, 0
  v_dot2_f32_bf16 v15, v136, v9, 0
  v_dot2_f32_bf16 v16, v140, v9, 0
  v_dot2_f32_bf16 v13, v129, v10, v13
  v_dot2_f32_bf16 v14, v133, v10, v14
  v_dot2_f32_bf16 v15, v137, v10, v15
  v_dot2_f32_bf16 v16, v141, v10, v16
  v_dot2_f32_bf16 v13, v130, v11, v13
  v_dot2_f32_bf16 v14, v134, v11, v14
  v_dot2_f32_bf16 v15, v138, v11, v15
  v_dot2_f32_bf16 v16, v142, v11, v16
  v_dot2_f32_bf16 v13, v131, v12, v13
  v_dot2_f32_bf16 v14, v135, v12, v14
  v_dot2_f32_bf16 v15, v139, v12, v15
  v_dot2_f32_bf16 v16, v143, v12, v16
  v_readfirstlane_b32 s24, v54
  s_mov_b64 exec, 1
  s_or_b32 s24, s24, s76
  s_cmp_ge_u32 s24, s64
  s_cselect_b32 s76, 512, 0
  s_cselect_b32 s25, 0, 1
  v_mov_b32 v54, s25
  s_add_u32 s25, s24, s80
  s_and_b32 s25, s25, 511
  s_lshl_b32 s25, s25, 12
  s_add_u32 s25, s25, s66
  s_cmp_lt_u32 s24, 512
  s_cselect_b32 s70, s25, 0x8000000
  s_mov_b64 exec, -1
  buffer_load_dwordx4 v[128:131], v2, s[8:11], s70 offen offset:0 nt
  buffer_load_dwordx4 v[132:135], v2, s[8:11], s70 offen offset:1024 nt
  buffer_load_dwordx4 v[136:139], v2, s[8:11], s70 offen offset:2048 nt
  buffer_load_dwordx4 v[140:143], v2, s[8:11], s70 offen offset:3072 nt
  v_add_f32_dpp v13, v13, v13 row_ror:8 row_mask:0xf bank_mask:0xf
  v_add_f32_dpp v14, v14, v14 row_ror:8 row_mask:0xf bank_mask:0xf
  v_add_f32_dpp v15, v15, v15 row_ror:8 row_mask:0xf bank_mask:0xf
  v_add_f32_dpp v16, v16, v16 row_ror:8 row_mask:0xf bank_mask:0xf
  v_add_f32_dpp v13, v13, v13 row_ror:4 row_mask:0xf bank_mask:0xf
  v_add_f32_dpp v14, v14, v14 row_ror:4 row_mask:0xf bank_mask:0xf
  v_add_f32_dpp v15, v15, v15 row_ror:4 row_mask:0xf bank_mask:0xf
  v_add_f32_dpp v16, v16, v16 row_ror:4 row_mask:0xf bank_mask:0xf
  v_add_f32_dpp v13, v13, v13 row_ror:2 row_mask:0xf bank_mask:0xf
  v_add_f32_dpp v14, v14, v14 row_ror:2 row_mask:0xf bank_mask:0xf
  v_add_f32_dpp v15, v15, v15 row_ror:2 row_mask:0xf bank_mask:0xf
  v_add_f32_dpp v16, v16, v16 row_ror:2 row_mask:0xf bank_mask:0xf
  v_add_f32_dpp v13, v13, v13 row_ror:1 row_mask:0xf bank_mask:0xf
  v_add_f32_dpp v14, v14, v14 row_ror:1 row_mask:0xf bank_mask:0xf
  v_add_f32_dpp v15, v15, v15 row_ror:1 row_mask:0xf bank_mask:0xf
  v_add_f32_dpp v16, v16, v16 row_ror:1 row_mask:0xf bank_mask:0xf
  v_cvt_pk_bf16_f32 v17, v13, v14
  v_cvt_pk_bf16_f32 v18, v15, v16
  v_lshlrev_b32 v13, 16, v17
  v_and_b32 v14, 0xffff0000, v17
  v_lshlrev_b32 v15, 16, v18
  v_and_b32 v16, 0xffff0000, v18
  v_mul_f32 v13, s26, v13
  v_mul_f32 v14, s26, v14
  v_mul_f32 v15, s26, v15
  v_mul_f32 v16, s26, v16
  v_cvt_pk_bf16_f32 v17, v13, v14
  v_cvt_pk_bf16_f32 v18, v15, v16
  v_lshlrev_b32 v13, 16, v17
  v_and_b32 v14, 0xffff0000, v17
  v_lshlrev_b32 v15, 16, v18
  v_and_b32 v16, 0xffff0000, v18
  v_max3_f32 v20, v13, v14, v19
  v_max3_f32 v20, v15, v16, v20
  v_mov_b32 v21, v20
  s_nop 1
  v_permlane16_swap_b32 v20, v21
  v_max_f32 v20, v20, v21
  v_mov_b32 v21, v20
  s_nop 1
  v_permlane32_swap_b32 v20, v21
  v_max_f32 v20, v20, v21
  v_sub_f32 v22, v19, v20
  v_mul_f32 v23, 0x3fb8aa3b, v20
  v_mul_f32 v22, 0x3fb8aa3b, v22
  v_mov_b32 v19, v20
  v_exp_f32 v22, v22
  v_mov_b32 v21, 0x3fb8aa3b
  v_fma_f32 v13, v13, v21, -v23
  v_fma_f32 v14, v14, v21, -v23
  v_fma_f32 v15, v15, v21, -v23
  v_fma_f32 v16, v16, v21, -v23
  v_exp_f32 v13, v13
  v_exp_f32 v14, v14
  v_exp_f32 v15, v15
  v_exp_f32 v16, v16
  v_mul_f32 v28, v22, v28
  v_mul_f32 v29, v22, v29
  v_mul_f32 v30, v22, v30
  v_mul_f32 v31, v22, v31
  v_cvt_pk_bf16_f32 v48, v13, v13
  v_cvt_pk_bf16_f32 v49, v14, v14
  v_cvt_pk_bf16_f32 v50, v15, v15
  v_cvt_pk_bf16_f32 v51, v16, v16
  v_add_f32 v17, v13, v14
  v_add_f32 v18, v15, v16
  v_and_b32 v32, v48, v5
  v_and_b32 v33, v48, v6
  v_and_b32 v34, v48, v7
  v_and_b32 v35, v48, v8
  v_and_b32 v36, v49, v5
  v_and_b32 v37, v49, v6
  v_and_b32 v38, v49, v7
  v_and_b32 v39, v49, v8
  v_and_b32 v40, v50, v5
  v_and_b32 v41, v50, v6
  v_and_b32 v42, v50, v7
  v_and_b32 v43, v50, v8
  v_and_b32 v44, v51, v5
  v_and_b32 v45, v51, v6
  v_and_b32 v46, v51, v7
  v_and_b32 v47, v51, v8
  v_add_f32 v17, v17, v18
  v_fma_f32 v24, v24, v22, v17
  s_waitcnt vmcnt(36)
  v_mfma_f32_16x16x32_bf16 v[28:31], v[144:147], v[32:35], v[28:31]
  v_mfma_f32_16x16x32_bf16 v[28:31], v[148:151], v[36:39], v[28:31]
  v_mfma_f32_16x16x32_bf16 v[28:31], v[152:155], v[40:43], v[28:31]
  v_mfma_f32_16x16x32_bf16 v[28:31], v[156:159], v[44:47], v[28:31]
  buffer_load_dwordx4 v[144:147], v2, s[12:15], s70 offen offset:0 nt
  buffer_load_dwordx4 v[148:151], v2, s[12:15], s70 offen offset:1024 nt
  buffer_load_dwordx4 v[152:155], v2, s[12:15], s70 offen offset:2048 nt
  buffer_load_dwordx4 v[156:159], v2, s[12:15], s70 offen offset:3072 nt
  s_cmp_ge_u32 s71, 0x8000000
  s_cbranch_scc1 L_sdone
  s_waitcnt vmcnt(36)
  v_dot2_f32_bf16 v13, v160, v9, 0
  v_dot2_f32_bf16 v14, v164, v9, 0
  v_dot2_f32_bf16 v15, v168, v9, 0
  v_dot2_f32_bf16 v16, v172, v9, 0
  v_dot2_f32_bf16 v13, v161, v10, v13
  v_dot2_f32_bf16 v14, v165, v10, v14
  v_dot2_f32_bf16 v15, v169, v10, v15
  v_dot2_f32_bf16 v16, v173, v10, v16
  v_dot2_f32_bf16 v13, v162, v11, v13
  v_dot2_f32_bf16 v14, v166, v11, v14
  v_dot2_f32_bf16 v15, v170, v11, v15
  v_dot2_f32_bf16 v16, v174, v11, v16
  v_dot2_f32_bf16 v13, v163, v12, v13
  v_dot2_f32_bf16 v14, v167, v12, v14
  v_dot2_f32_bf16 v15, v171, v12, v15
  v_dot2_f32_bf16 v16, v175, v12, v16
  v_readfirstlane_b32 s24, v55
  s_mov_b64 exec, 1
  s_or_b32 s24, s24, s77
  s_cmp_ge_u32 s24, s64
  s_cselect_b32 s77, 512, 0
  s_cselect_b32 s25, 0, 1
  v_mov_b32 v55, s25
  s_add_u32 s25, s24, s80
  s_and_b32 s25, s25, 511
  s_lshl_b32 s25, s25, 12
  s_add_u32 s25, s25, s66
  s_cmp_lt_u32 s24, 512
  s_cselect_b32 s71, s25, 0x8000000
  s_mov_b64 exec, -1
  buffer_load_dwordx4 v[160:163], v2, s[8:11], s71 offen offset:0 nt
  buffer_load_dwordx4 v[164:167], v2, s[8:11], s71 offen offset:1024 nt
  buffer_load_dwordx4 v[168:171], v2, s[8:11], s71 offen offset:2048 nt
  buffer_load_dwordx4 v[172:175], v2, s[8:11], s71 offen offset:3072 nt
  v_add_f32_dpp v13, v13, v13 row_ror:8 row_mask:0xf bank_mask:0xf
  v_add_f32_dpp v14, v14, v14 row_ror:8 row_mask:0xf bank_mask:0xf
  v_add_f32_dpp v15, v15, v15 row_ror:8 row_mask:0xf bank_mask:0xf
  v_add_f32_dpp v16, v16, v16 row_ror:8 row_mask:0xf bank_mask:0xf
  v_add_f32_dpp v13, v13, v13 row_ror:4 row_mask:0xf bank_mask:0xf
  v_add_f32_dpp v14, v14, v14 row_ror:4 row_mask:0xf bank_mask:0xf
  v_add_f32_dpp v15, v15, v15 row_ror:4 row_mask:0xf bank_mask:0xf
  v_add_f32_dpp v16, v16, v16 row_ror:4 row_mask:0xf bank_mask:0xf
  v_add_f32_dpp v13, v13, v13 row_ror:2 row_mask:0xf bank_mask:0xf
  v_add_f32_dpp v14, v14, v14 row_ror:2 row_mask:0xf bank_mask:0xf
  v_add_f32_dpp v15, v15, v15 row_ror:2 row_mask:0xf bank_mask:0xf
  v_add_f32_dpp v16, v16, v16 row_ror:2 row_mask:0xf bank_mask:0xf
  v_add_f32_dpp v13, v13, v13 row_ror:1 row_mask:0xf bank_mask:0xf
  v_add_f32_dpp v14, v14, v14 row_ror:1 row_mask:0xf bank_mask:0xf
  v_add_f32_dpp v15, v15, v15 row_ror:1 row_mask:0xf bank_mask:0xf
  v_add_f32_dpp v16, v16, v16 row_ror:1 row_mask:0xf bank_mask:0xf
  v_cvt_pk_bf16_f32 v17, v13, v14
  v_cvt_pk_bf16_f32 v18, v15, v16
  v_lshlrev_b32 v13, 16, v17
  v_and_b32 v14, 0xffff0000, v17
  v_lshlrev_b32 v15, 16, v18
  v_and_b32 v16, 0xffff0000, v18
  v_mul_f32 v13, s26, v13
  v_mul_f32 v14, s26, v14
  v_mul_f32 v15, s26, v15
  v_mul_f32 v16, s26, v16
  v_cvt_pk_bf16_f32 v17, v13, v14
  v_cvt_pk_bf16_f32 v18, v15, v16
  v_lshlrev_b32 v13, 16, v17
  v_and_b32 v14, 0xffff0000, v17
  v_lshlrev_b32 v15, 16, v18
  v_and_b32 v16, 0xffff0000, v18
  v_max3_f32 v20, v13, v14, v19
  v_max3_f32 v20, v15, v16, v20
  v_mov_b32 v21, v20
  s_nop 1
  v_permlane16_swap_b32 v20, v21
  v_max_f32 v20, v20, v21
  v_mov_b32 v21, v20
  s_nop 1
  v_permlane32_swap_b32 v20, v21
  v_max_f32 v20, v20, v21
  v_sub_f32 v22, v19, v20
  v_mul_f32 v23, 0x3fb8aa3b, v20
  v_mul_f32 v22, 0x3fb8aa3b, v22
  v_mov_b32 v19, v20
  v_exp_f32 v22, v22
  v_mov_b32 v21, 0x3fb8aa3b
  v_fma_f32 v13, v13, v21, -v23
  v_fma_f32 v14, v14, v21, -v23
  v_fma_f32 v15, v15, v21, -v23
  v_fma_f32 v16, v16, v21, -v23
  v_exp_f32 v13, v13
  v_exp_f32 v14, v14
  v_exp_f32 v15, v15
  v_exp_f32 v16, v16
  v_mul_f32 v28, v22, v28
  v_mul_f32 v29, v22, v29
  v_mul_f32 v30, v22, v30
  v_mul_f32 v31, v22, v31
  v_cvt_pk_bf16_f32 v48, v13, v13
  v_cvt_pk_bf16_f32 v49, v14, v14
  v_cvt_pk_bf16_f32 v50, v15, v15
  v_cvt_pk_bf16_f32 v51, v16, v16
  v_add_f32 v17, v13, v14
  v_add_f32 v18, v15, v16
  v_and_b32 v32, v48, v5
  v_and_b32 v33, v48, v6
  v_and_b32 v34, v48, v7
  v_and_b32 v35, v48, v8
  v_and_b32 v36, v49, v5
  v_and_b32 v37, v49, v6
  v_and_b32 v38, v49, v7
  v_and_b32 v39, v49, v8
  v_and_b32 v40, v50, v5
  v_and_b32 v41, v50, v6
  v_and_b32 v42, v50, v7
  v_and_b32 v43, v50, v8
  v_and_b32 v44, v51, v5
  v_and_b32 v45, v51, v6
  v_and_b32 v46, v51, v7
  v_and_b32 v47, v51, v8
  v_add_f32 v17, v17, v18
  v_fma_f32 v24, v24, v22, v17
  s_waitcnt vmcnt(36)
  v_mfma_f32_16x16x32_bf16 v[28:31], v[176:179], v[32:35], v[28:31]
  v_mfma_f32_16x16x32_bf16 v[28:31], v[180:183], v[36:39], v[28:31]
  v_mfma_f32_16x16x32_bf16 v[28:31], v[184:187], v[40:43], v[28:31]
  v_mfma_f32_16x16x32_bf16 v[28:31], v[188:191], v[44:47], v[28:31]
  buffer_load_dwordx4 v[176:179], v2, s[12:15], s71 offen offset:0 nt
  buffer_load_dwordx4 v[180:183], v2, s[12:15], s71 offen offset:1024 nt
  buffer_load_dwordx4 v[184:187], v2, s[12:15], s71 offen offset:2048 nt
  buffer_load_dwordx4 v[188:191], v2, s[12:15], s71 offen offset:3072 nt
  s_cmp_ge_u32 s72, 0x8000000
  s_cbranch_scc1 L_sdone
  s_waitcnt vmcnt(36)
  v_dot2_f32_bf16 v13, v192, v9, 0
  v_dot2_f32_bf16 v14, v196, v9, 0
  v_dot2_f32_bf16 v15, v200, v9, 0
  v_dot2_f32_bf16 v16, v204, v9, 0
  v_dot2_f32_bf16 v13, v193, v10, v13
  v_dot2_f32_bf16 v14, v197, v10, v14
  v_dot2_f32_bf16 v15, v201, v10, v15
  v_dot2_f32_bf16 v16, v205, v10, v16
  v_dot2_f32_bf16 v13, v194, v11, v13
  v_dot2_f32_bf16 v14, v198, v11, v14
  v_dot2_f32_bf16 v15, v202, v11, v15
  v_dot2_f32_bf16 v16, v206, v11, v16
  v_dot2_f32_bf16 v13, v195, v12, v13
  v_dot2_f32_bf16 v14, v199, v12, v14
  v_dot2_f32_bf16 v15, v203, v12, v15
  v_dot2_f32_bf16 v16, v207, v12, v16
  v_readfirstlane_b32 s24, v56
  s_mov_b64 exec, 1
  s_or_b32 s24, s24, s78
  s_cmp_ge_u32 s24, s64
  s_cselect_b32 s78, 512, 0
  s_cselect_b32 s25, 0, 1
  v_mov_b32 v56, s25
  s_add_u32 s25, s24, s80
  s_and_b32 s25, s25, 511
  s_lshl_b32 s25, s25, 12
  s_add_u32 s25, s25, s66
  s_cmp_lt_u32 s24, 512
  s_cselect_b32 s72, s25, 0x8000000
  s_mov_b64 exec, -1
  buffer_load_dwordx4 v[192:195], v2, s[8:11], s72 offen offset:0 nt
  buffer_load_dwordx4 v[196:199], v2, s[8:11], s72 offen offset:1024 nt
  buffer_load_dwordx4 v[200:203], v2, s[8:11], s72 offen offset:2048 nt
  buffer_load_dwordx4 v[204:207], v2, s[8:11], s72 offen offset:3072 nt
  v_add_f32_dpp v13, v13, v13 row_ror:8 row_mask:0xf bank_mask:0xf
  v_add_f32_dpp v14, v14, v14 row_ror:8 row_mask:0xf bank_mask:0xf
  v_add_f32_dpp v15, v15, v15 row_ror:8 row_mask:0xf bank_mask:0xf
  v_add_f32_dpp v16, v16, v16 row_ror:8 row_mask:0xf bank_mask:0xf
  v_add_f32_dpp v13, v13, v13 row_ror:4 row_mask:0xf bank_mask:0xf
  v_add_f32_dpp v14, v14, v14 row_ror:4 row_mask:0xf bank_mask:0xf
  v_add_f32_dpp v15, v15, v15 row_ror:4 row_mask:0xf bank_mask:0xf
  v_add_f32_dpp v16, v16, v16 row_ror:4 row_mask:0xf bank_mask:0xf
  v_add_f32_dpp v13, v13, v13 row_ror:2 row_mask:0xf bank_mask:0xf
  v_add_f32_dpp v14, v14, v14 row_ror:2 row_mask:0xf bank_mask:0xf
  v_add_f32_dpp v15, v15, v15 row_ror:2 row_mask:0xf bank_mask:0xf
  v_add_f32_dpp v16, v16, v16 row_ror:2 row_mask:0xf bank_mask:0xf
  v_add_f32_dpp v13, v13, v13 row_ror:1 row_mask:0xf bank_mask:0xf
  v_add_f32_dpp v14, v14, v14 row_ror:1 row_mask:0xf bank_mask:0xf
  v_add_f32_dpp v15, v15, v15 row_ror:1 row_mask:0xf bank_mask:0xf
  v_add_f32_dpp v16, v16, v16 row_ror:1 row_mask:0xf bank_mask:0xf
  v_cvt_pk_bf16_f32 v17, v13, v14
  v_cvt_pk_bf16_f32 v18, v15, v16
  v_lshlrev_b32 v13, 16, v17
  v_and_b32 v14, 0xffff0000, v17
  v_lshlrev_b32 v15, 16, v18
  v_and_b32 v16, 0xffff0000, v18
  v_mul_f32 v13, s26, v13
  v_mul_f32 v14, s26, v14
  v_mul_f32 v15, s26, v15
  v_mul_f32 v16, s26, v16
  v_cvt_pk_bf16_f32 v17, v13, v14
  v_cvt_pk_bf16_f32 v18, v15, v16
  v_lshlrev_b32 v13, 16, v17
  v_and_b32 v14, 0xffff0000, v17
  v_lshlrev_b32 v15, 16, v18
  v_and_b32 v16, 0xffff0000, v18
  v_max3_f32 v20, v13, v14, v19
  v_max3_f32 v20, v15, v16, v20
  v_mov_b32 v21, v20
  s_nop 1
  v_permlane16_swap_b32 v20, v21
  v_max_f32 v20, v20, v21
  v_mov_b32 v21, v20
  s_nop 1
  v_permlane32_swap_b32 v20, v21
  v_max_f32 v20, v20, v21
  v_sub_f32 v22, v19, v20
  v_mul_f32 v23, 0x3fb8aa3b, v20
  v_mul_f32 v22, 0x3fb8aa3b, v22
  v_mov_b32 v19, v20
  v_exp_f32 v22, v22
  v_mov_b32 v21, 0x3fb8aa3b
  v_fma_f32 v13, v13, v21, -v23
  v_fma_f32 v14, v14, v21, -v23
  v_fma_f32 v15, v15, v21, -v23
  v_fma_f32 v16, v16, v21, -v23
  v_exp_f32 v13, v13
  v_exp_f32 v14, v14
  v_exp_f32 v15, v15
  v_exp_f32 v16, v16
  v_mul_f32 v28, v22, v28
  v_mul_f32 v29, v22, v29
  v_mul_f32 v30, v22, v30
  v_mul_f32 v31, v22, v31
  v_cvt_pk_bf16_f32 v48, v13, v13
  v_cvt_pk_bf16_f32 v49, v14, v14
  v_cvt_pk_bf16_f32 v50, v15, v15
  v_cvt_pk_bf16_f32 v51, v16, v16
  v_add_f32 v17, v13, v14
  v_add_f32 v18, v15, v16
  v_and_b32 v32, v48, v5
  v_and_b32 v33, v48, v6
  v_and_b32 v34, v48, v7
  v_and_b32 v35, v48, v8
  v_and_b32 v36, v49, v5
  v_and_b32 v37, v49, v6
  v_and_b32 v38, v49, v7
  v_and_b32 v39, v49, v8
  v_and_b32 v40, v50, v5
  v_and_b32 v41, v50, v6
  v_and_b32 v42, v50, v7
  v_and_b32 v43, v50, v8
  v_and_b32 v44, v51, v5
  v_and_b32 v45, v51, v6
  v_and_b32 v46, v51, v7
  v_and_b32 v47, v51, v8
  v_add_f32 v17, v17, v18
  v_fma_f32 v24, v24, v22, v17
  s_waitcnt vmcnt(36)
  v_mfma_f32_16x16x32_bf16 v[28:31], v[208:211], v[32:35], v[28:31]
  v_mfma_f32_16x16x32_bf16 v[28:31], v[212:215], v[36:39], v[28:31]
  v_mfma_f32_16x16x32_bf16 v[28:31], v[216:219], v[40:43], v[28:31]
  v_mfma_f32_16x16x32_bf16 v[28:31], v[220:223], v[44:47], v[28:31]
  buffer_load_dwordx4 v[208:211], v2, s[12:15], s72 offen offset:0 nt
  buffer_load_dwordx4 v[212:215], v2, s[12:15], s72 offen offset:1024 nt
  buffer_load_dwordx4 v[216:219], v2, s[12:15], s72 offen offset:2048 nt
  buffer_load_dwordx4 v[220:223], v2, s[12:15], s72 offen offset:3072 nt
  s_cmp_ge_u32 s68, 0x8000000
  s_cbranch_scc1 L_sdone
  s_waitcnt vmcnt(36)
  v_dot2_f32_bf16 v13, v64, v9, 0
  v_dot2_f32_bf16 v14, v68, v9, 0
  v_dot2_f32_bf16 v15, v72, v9, 0
  v_dot2_f32_bf16 v16, v76, v9, 0
  v_dot2_f32_bf16 v13, v65, v10, v13
  v_dot2_f32_bf16 v14, v69, v10, v14
  v_dot2_f32_bf16 v15, v73, v10, v15
  v_dot2_f32_bf16 v16, v77, v10, v16
  v_dot2_f32_bf16 v13, v66, v11, v13
  v_dot2_f32_bf16 v14, v70, v11, v14
  v_dot2_f32_bf16 v15, v74, v11, v15
  v_dot2_f32_bf16 v16, v78, v11, v16
  v_dot2_f32_bf16 v13, v67, v12, v13
  v_dot2_f32_bf16 v14, v71, v12, v14
  v_dot2_f32_bf16 v15, v75, v12, v15
  v_dot2_f32_bf16 v16, v79, v12, v16
  v_readfirstlane_b32 s24, v52
  s_mov_b64 exec, 1
  s_or_b32 s24, s24, s74
  s_cmp_ge_u32 s24, s64
  s_cselect_b32 s74, 512, 0
  s_cselect_b32 s25, 0, 1
  v_mov_b32 v52, s25
  s_add_u32 s25, s24, s80
  s_and_b32 s25, s25, 511
  s_lshl_b32 s25, s25, 12
  s_add_u32 s25, s25, s66
  s_cmp_lt_u32 s24, 512
  s_cselect_b32 s68, s25, 0x8000000
  buffer_atomic_add v52, off, s[16:19], s84 sc0 sc1
  s_mov_b64 exec, -1
  buffer_load_dwordx4 v[64:67], v2, s[8:11], s68 offen offset:0 nt
  buffer_load_dwordx4 v[68:71], v2, s[8:11], s68 offen offset:1024 nt
  buffer_load_dwordx4 v[72:75], v2, s[8:11], s68 offen offset:2048 nt
  buffer_load_dwordx4 v[76:79], v2, s[8:11], s68 offen offset:3072 nt
  v_add_f32_dpp v13, v13, v13 row_ror:8 row_mask:0xf bank_mask:0xf
  v_add_f32_dpp v14, v14, v14 row_ror:8 row_mask:0xf bank_mask:0xf
  v_add_f32_dpp v15, v15, v15 row_ror:8 row_mask:0xf bank_mask:0xf
  v_add_f32_dpp v16, v16, v16 row_ror:8 row_mask:0xf bank_mask:0xf
  v_add_f32_dpp v13, v13, v13 row_ror:4 row_mask:0xf bank_mask:0xf
  v_add_f32_dpp v14, v14, v14 row_ror:4 row_mask:0xf bank_mask:0xf
  v_add_f32_dpp v15, v15, v15 row_ror:4 row_mask:0xf bank_mask:0xf
  v_add_f32_dpp v16, v16, v16 row_ror:4 row_mask:0xf bank_mask:0xf
  v_add_f32_dpp v13, v13, v13 row_ror:2 row_mask:0xf bank_mask:0xf
  v_add_f32_dpp v14, v14, v14 row_ror:2 row_mask:0xf bank_mask:0xf
  v_add_f32_dpp v15, v15, v15 row_ror:2 row_mask:0xf bank_mask:0xf
  v_add_f32_dpp v16, v16, v16 row_ror:2 row_mask:0xf bank_mask:0xf
  v_add_f32_dpp v13, v13, v13 row_ror:1 row_mask:0xf bank_mask:0xf
  v_add_f32_dpp v14, v14, v14 row_ror:1 row_mask:0xf bank_mask:0xf
  v_add_f32_dpp v15, v15, v15 row_ror:1 row_mask:0xf bank_mask:0xf
  v_add_f32_dpp v16, v16, v16 row_ror:1 row_mask:0xf bank_mask:0xf
  v_cvt_pk_bf16_f32 v17, v13, v14
  v_cvt_pk_bf16_f32 v18, v15, v16
  v_lshlrev_b32 v13, 16, v17
  v_and_b32 v14, 0xffff0000, v17
  v_lshlrev_b32 v15, 16, v18
  v_and_b32 v16, 0xffff0000, v18
  v_mul_f32 v13, s26, v13
  v_mul_f32 v14, s26, v14
  v_mul_f32 v15, s26, v15
  v_mul_f32 v16, s26, v16
  v_cvt_pk_bf16_f32 v17, v13, v14
  v_cvt_pk_bf16_f32 v18, v15, v16
  v_lshlrev_b32 v13, 16, v17
  v_and_b32 v14, 0xffff0000, v17
  v_lshlrev_b32 v15, 16, v18
  v_and_b32 v16, 0xffff0000, v18
  v_max3_f32 v20, v13, v14, v19
  v_max3_f32 v20, v15, v16, v20
  v_mov_b32 v21, v20
  s_nop 1
  v_permlane16_swap_b32 v20, v21
  v_max_f32 v20, v20, v21
  v_mov_b32 v21, v20
  s_nop 1
  v_permlane32_swap_b32 v20, v21
  v_max_f32 v20, v20, v21
  v_sub_f32 v22, v19, v20
  v_mul_f32 v23, 0x3fb8aa3b, v20
  v_mul_f32 v22, 0x3fb8aa3b, v22
  v_mov_b32 v19, v20
  v_exp_f32 v22, v22
  v_mov_b32 v21, 0x3fb8aa3b
  v_fma_f32 v13, v13, v21, -v23
  v_fma_f32 v14, v14, v21, -v23
  v_fma_f32 v15, v15, v21, -v23
  v_fma_f32 v16, v16, v21, -v23
  v_exp_f32 v13, v13
  v_exp_f32 v14, v14
  v_exp_f32 v15, v15
  v_exp_f32 v16, v16
  v_mul_f32 v28, v22, v28
  v_mul_f32 v29, v22, v29
  v_mul_f32 v30, v22, v30
  v_mul_f32 v31, v22, v31
  v_cvt_pk_bf16_f32 v48, v13, v13
  v_cvt_pk_bf16_f32 v49, v14, v14
  v_cvt_pk_bf16_f32 v50, v15, v15
  v_cvt_pk_bf16_f32 v51, v16, v16
  v_add_f32 v17, v13, v14
  v_add_f32 v18, v15, v16
  v_and_b32 v32, v48, v5
  v_and_b32 v33, v48, v6
  v_and_b32 v34, v48, v7
  v_and_b32 v35, v48, v8
  v_and_b32 v36, v49, v5
  v_and_b32 v37, v49, v6
  v_and_b32 v38, v49, v7
  v_and_b32 v39, v49, v8
  v_and_b32 v40, v50, v5
  v_and_b32 v41, v50, v6
  v_and_b32 v42, v50, v7
  v_and_b32 v43, v50, v8
  v_and_b32 v44, v51, v5
  v_and_b32 v45, v51, v6
  v_and_b32 v46, v51, v7
  v_and_b32 v47, v51, v8
  v_add_f32 v17, v17, v18
  v_fma_f32 v24, v24, v22, v17
  s_waitcnt vmcnt(37)
  v_mfma_f32_16x16x32_bf16 v[28:31], v[80:83], v[32:35], v[28:31]
  v_mfma_f32_16x16x32_bf16 v[28:31], v[84:87], v[36:39], v[28:31]
  v_mfma_f32_16x16x32_bf16 v[28:31], v[88:91], v[40:43], v[28:31]
  v_mfma_f32_16x16x32_bf16 v[28:31], v[92:95], v[44:47], v[28:31]
  buffer_load_dwordx4 v[80:83], v2, s[12:15], s68 offen offset:0 nt
  buffer_load_dwordx4 v[84:87], v2, s[12:15], s68 offen offset:1024 nt
  buffer_load_dwordx4 v[88:91], v2, s[12:15], s68 offen offset:2048 nt
  buffer_load_dwordx4 v[92:95], v2, s[12:15], s68 offen offset:3072 nt
  s_cmp_ge_u32 s69, 0x8000000
  s_cbranch_scc1 L_sdone
  s_waitcnt vmcnt(36)
  v_dot2_f32_bf16 v13, v96, v9, 0
  v_dot2_f32_bf16 v14, v100, v9, 0
  v_dot2_f32_bf16 v15, v104, v9, 0
  v_dot2_f32_bf16 v16, v108, v9, 0
  v_dot2_f32_bf16 v13, v97, v10, v13
  v_dot2_f32_bf16 v14, v101, v10, v14
  v_dot2_f32_bf16 v15, v105, v10, v15
  v_dot2_f32_bf16 v16, v109, v10, v16
  v_dot2_f32_bf16 v13, v98, v11, v13
  v_dot2_f32_bf16 v14, v102, v11, v14
  v_dot2_f32_bf16 v15, v106, v11, v15
  v_dot2_f32_bf16 v16, v110, v11, v16
  v_dot2_f32_bf16 v13, v99, v12, v13
  v_dot2_f32_bf16 v14, v103, v12, v14
  v_dot2_f32_bf16 v15, v107, v12, v15
  v_dot2_f32_bf16 v16, v111, v12, v16
  v_readfirstlane_b32 s24, v53
  s_mov_b64 exec, 1
  s_or_b32 s24, s24, s75
  s_cmp_ge_u32 s24, s64
  s_cselect_b32 s75, 512, 0
  s_cselect_b32 s25, 0, 1
  v_mov_b32 v53, s25
  s_add_u32 s25, s24, s80
  s_and_b32 s25, s25, 511
  s_lshl_b32 s25, s25, 12
  s_add_u32 s25, s25, s66
  s_cmp_lt_u32 s24, 512
  s_cselect_b32 s69, s25, 0x8000000
  buffer_atomic_add v53, off, s[16:19], s84 sc0 sc1
  s_mov_b64 exec, -1
  buffer_load_dwordx4 v[96:99], v2, s[8:11], s69 offen offset:0 nt
  buffer_load_dwordx4 v[100:103], v2, s[8:11], s69 offen offset:1024 nt
  buffer_load_dwordx4 v[104:107], v2, s[8:11], s69 offen offset:2048 nt
  buffer_load_dwordx4 v[108:111], v2, s[8:11], s69 offen offset:3072 nt
  v_add_f32_dpp v13, v13, v13 row_ror:8 row_mask:0xf bank_mask:0xf
  v_add_f32_dpp v14, v14, v14 row_ror:8 row_mask:0xf bank_mask:0xf
  v_add_f32_dpp v15, v15, v15 row_ror:8 row_mask:0xf bank_mask:0xf
  v_add_f32_dpp v16, v16, v16 row_ror:8 row_mask:0xf bank_mask:0xf
  v_add_f32_dpp v13, v13, v13 row_ror:4 row_mask:0xf bank_mask:0xf
  v_add_f32_dpp v14, v14, v14 row_ror:4 row_mask:0xf bank_mask:0xf
  v_add_f32_dpp v15, v15, v15 row_ror:4 row_mask:0xf bank_mask:0xf
  v_add_f32_dpp v16, v16, v16 row_ror:4 row_mask:0xf bank_mask:0xf
  v_add_f32_dpp v13, v13, v13 row_ror:2 row_mask:0xf bank_mask:0xf
  v_add_f32_dpp v14, v14, v14 row_ror:2 row_mask:0xf bank_mask:0xf
  v_add_f32_dpp v15, v15, v15 row_ror:2 row_mask:0xf bank_mask:0xf
  v_add_f32_dpp v16, v16, v16 row_ror:2 row_mask:0xf bank_mask:0xf
  v_add_f32_dpp v13, v13, v13 row_ror:1 row_mask:0xf bank_mask:0xf
  v_add_f32_dpp v14, v14, v14 row_ror:1 row_mask:0xf bank_mask:0xf
  v_add_f32_dpp v15, v15, v15 row_ror:1 row_mask:0xf bank_mask:0xf
  v_add_f32_dpp v16, v16, v16 row_ror:1 row_mask:0xf bank_mask:0xf
  v_cvt_pk_bf16_f32 v17, v13, v14
  v_cvt_pk_bf16_f32 v18, v15, v16
  v_lshlrev_b32 v13, 16, v17
  v_and_b32 v14, 0xffff0000, v17
  v_lshlrev_b32 v15, 16, v18
  v_and_b32 v16, 0xffff0000, v18
  v_mul_f32 v13, s26, v13
  v_mul_f32 v14, s26, v14
  v_mul_f32 v15, s26, v15
  v_mul_f32 v16, s26, v16
  v_cvt_pk_bf16_f32 v17, v13, v14
  v_cvt_pk_bf16_f32 v18, v15, v16
  v_lshlrev_b32 v13, 16, v17
  v_and_b32 v14, 0xffff0000, v17
  v_lshlrev_b32 v15, 16, v18
  v_and_b32 v16, 0xffff0000, v18
  v_max3_f32 v20, v13, v14, v19
  v_max3_f32 v20, v15, v16, v20
  v_mov_b32 v21, v20
  s_nop 1
  v_permlane16_swap_b32 v20, v21
  v_max_f32 v20, v20, v21
  v_mov_b32 v21, v20
  s_nop 1
  v_permlane32_swap_b32 v20, v21
  v_max_f32 v20, v20, v21
  v_sub_f32 v22, v19, v20
  v_mul_f32 v23, 0x3fb8aa3b, v20
  v_mul_f32 v22, 0x3fb8aa3b, v22
  v_mov_b32 v19, v20
  v_exp_f32 v22, v22
  v_mov_b32 v21, 0x3fb8aa3b
  v_fma_f32 v13, v13, v21, -v23
  v_fma_f32 v14, v14, v21, -v23
  v_fma_f32 v15, v15, v21, -v23
  v_fma_f32 v16, v16, v21, -v23
  v_exp_f32 v13, v13
  v_exp_f32 v14, v14
  v_exp_f32 v15, v15
  v_exp_f32 v16, v16
  v_mul_f32 v28, v22, v28
  v_mul_f32 v29, v22, v29
  v_mul_f32 v30, v22, v30
  v_mul_f32 v31, v22, v31
  v_cvt_pk_bf16_f32 v48, v13, v13
  v_cvt_pk_bf16_f32 v49, v14, v14
  v_cvt_pk_bf16_f32 v50, v15, v15
  v_cvt_pk_bf16_f32 v51, v16, v16
  v_add_f32 v17, v13, v14
  v_add_f32 v18, v15, v16
  v_and_b32 v32, v48, v5
  v_and_b32 v33, v48, v6
  v_and_b32 v34, v48, v7
  v_and_b32 v35, v48, v8
  v_and_b32 v36, v49, v5
  v_and_b32 v37, v49, v6
  v_and_b32 v38, v49, v7
  v_and_b32 v39, v49, v8
  v_and_b32 v40, v50, v5
  v_and_b32 v41, v50, v6
  v_and_b32 v42, v50, v7
  v_and_b32 v43, v50, v8
  v_and_b32 v44, v51, v5
  v_and_b32 v45, v51, v6
  v_and_b32 v46, v51, v7
  v_and_b32 v47, v51, v8
  v_add_f32 v17, v17, v18
  v_fma_f32 v24, v24, v22, v17
  s_waitcnt vmcnt(37)
  v_mfma_f32_16x16x32_bf16 v[28:31], v[112:115], v[32:35], v[28:31]
  v_mfma_f32_16x16x32_bf16 v[28:31], v[116:119], v[36:39], v[28:31]
  v_mfma_f32_16x16x32_bf16 v[28:31], v[120:123], v[40:43], v[28:31]
  v_mfma_f32_16x16x32_bf16 v[28:31], v[124:127], v[44:47], v[28:31]
  buffer_load_dwordx4 v[112:115], v2, s[12:15], s69 offen offset:0 nt
  buffer_load_dwordx4 v[116:119], v2, s[12:15], s69 offen offset:1024 nt
  buffer_load_dwordx4 v[120:123], v2, s[12:15], s69 offen offset:2048 nt
  buffer_load_dwordx4 v[124:127], v2, s[12:15], s69 offen offset:3072 nt
  s_cmp_ge_u32 s70, 0x8000000
  s_cbranch_scc1 L_sdone
  s_waitcnt vmcnt(36)
  v_dot2_f32_bf16 v13, v128, v9, 0
  v_dot2_f32_bf16 v14, v132, v9, 0
  v_dot2_f32_bf16 v15, v136, v9, 0
  v_dot2_f32_bf16 v16, v140, v9, 0
  v_dot2_f32_bf16 v13, v129, v10, v13
  v_dot2_f32_bf16 v14, v133, v10, v14
  v_dot2_f32_bf16 v15, v137, v10, v15
  v_dot2_f32_bf16 v16, v141, v10, v16
  v_dot2_f32_bf16 v13, v130, v11, v13
  v_dot2_f32_bf16 v14, v134, v11, v14
  v_dot2_f32_bf16 v15, v138, v11, v15
  v_dot2_f32_bf16 v16, v142, v11, v16
  v_dot2_f32_bf16 v13, v131, v12, v13
  v_dot2_f32_bf16 v14, v135, v12, v14
  v_dot2_f32_bf16 v15, v139, v12, v15
  v_dot2_f32_bf16 v16, v143, v12, v16
  v_add_f32_dpp v13, v13, v13 row_ror:8 row_mask:0xf bank_mask:0xf
  v_add_f32_dpp v14, v14, v14 row_ror:8 row_mask:0xf bank_mask:0xf
  v_add_f32_dpp v15, v15, v15 row_ror:8 row_mask:0xf bank_mask:0xf
  v_add_f32_dpp v16, v16, v16 row_ror:8 row_mask:0xf bank_mask:0xf
  v_add_f32_dpp v13, v13, v13 row_ror:4 row_mask:0xf bank_mask:0xf
  v_add_f32_dpp v14, v14, v14 row_ror:4 row_mask:0xf bank_mask:0xf
  v_add_f32_dpp v15, v15, v15 row_ror:4 row_mask:0xf bank_mask:0xf
  v_add_f32_dpp v16, v16, v16 row_ror:4 row_mask:0xf bank_mask:0xf
  v_add_f32_dpp v13, v13, v13 row_ror:2 row_mask:0xf bank_mask:0xf
  v_add_f32_dpp v14, v14, v14 row_ror:2 row_mask:0xf bank_mask:0xf
  v_add_f32_dpp v15, v15, v15 row_ror:2 row_mask:0xf bank_mask:0xf
  v_add_f32_dpp v16, v16, v16 row_ror:2 row_mask:0xf bank_mask:0xf
  v_add_f32_dpp v13, v13, v13 row_ror:1 row_mask:0xf bank_mask:0xf
  v_add_f32_dpp v14, v14, v14 row_ror:1 row_mask:0xf bank_mask:0xf
  v_add_f32_dpp v15, v15, v15 row_ror:1 row_mask:0xf bank_mask:0xf
  v_add_f32_dpp v16, v16, v16 row_ror:1 row_mask:0xf bank_mask:0xf
  v_cvt_pk_bf16_f32 v17, v13, v14
  v_cvt_pk_bf16_f32 v18, v15, v16
  v_lshlrev_b32 v13, 16, v17
  v_and_b32 v14, 0xffff0000, v17
  v_lshlrev_b32 v15, 16, v18
  v_and_b32 v16, 0xffff0000, v18
  v_mul_f32 v13, s26, v13
  v_mul_f32 v14, s26, v14
  v_mul_f32 v15, s26, v15
  v_mul_f32 v16, s26, v16
  v_cvt_pk_bf16_f32 v17, v13, v14
  v_cvt_pk_bf16_f32 v18, v15, v16
  v_lshlrev_b32 v13, 16, v17
  v_and_b32 v14, 0xffff0000, v17
  v_lshlrev_b32 v15, 16, v18
  v_and_b32 v16, 0xffff0000, v18
  v_max3_f32 v20, v13, v14, v19
  v_max3_f32 v20, v15, v16, v20
  v_mov_b32 v21, v20
  s_nop 1
  v_permlane16_swap_b32 v20, v21
  v_max_f32 v20, v20, v21
  v_mov_b32 v21, v20
  s_nop 1
  v_permlane32_swap_b32 v20, v21
  v_max_f32 v20, v20, v21
  v_sub_f32 v22, v19, v20
  v_mul_f32 v23, 0x3fb8aa3b, v20
  v_mul_f32 v22, 0x3fb8aa3b, v22
  v_mov_b32 v19, v20
  v_exp_f32 v22, v22
  v_mov_b32 v21, 0x3fb8aa3b
  v_fma_f32 v13, v13, v21, -v23
  v_fma_f32 v14, v14, v21, -v23
  v_fma_f32 v15, v15, v21, -v23
  v_fma_f32 v16, v16, v21, -v23
  v_exp_f32 v13, v13
  v_exp_f32 v14, v14
  v_exp_f32 v15, v15
  v_exp_f32 v16, v16
  v_mul_f32 v28, v22, v28
  v_mul_f32 v29, v22, v29
  v_mul_f32 v30, v22, v30
  v_mul_f32 v31, v22, v31
  v_cvt_pk_bf16_f32 v48, v13, v13
  v_cvt_pk_bf16_f32 v49, v14, v14
  v_cvt_pk_bf16_f32 v50, v15, v15
  v_cvt_pk_bf16_f32 v51, v16, v16
  v_add_f32 v17, v13, v14
  v_add_f32 v18, v15, v16
  v_and_b32 v32, v48, v5
  v_and_b32 v33, v48, v6
  v_and_b32 v34, v48, v7
  v_and_b32 v35, v48, v8
  v_and_b32 v36, v49, v5
  v_and_b32 v37, v49, v6
  v_and_b32 v38, v49, v7
  v_and_b32 v39, v49, v8
  v_and_b32 v40, v50, v5
  v_and_b32 v41, v50, v6
  v_and_b32 v42, v50, v7
  v_and_b32 v43, v50, v8
  v_and_b32 v44, v51, v5
  v_and_b32 v45, v51, v6
  v_and_b32 v46, v51, v7
  v_and_b32 v47, v51, v8
  v_add_f32 v17, v17, v18
  v_fma_f32 v24, v24, v22, v17
  s_waitcnt vmcnt(32)
  v_mfma_f32_16x16x32_bf16 v[28:31], v[144:147], v[32:35], v[28:31]
  v_mfma_f32_16x16x32_bf16 v[28:31], v[148:151], v[36:39], v[28:31]
  v_mfma_f32_16x16x32_bf16 v[28:31], v[152:155], v[40:43], v[28:31]
  v_mfma_f32_16x16x32_bf16 v[28:31], v[156:159], v[44:47], v[28:31]
  s_cmp_ge_u32 s71, 0x8000000
  s_cbranch_scc1 L_sdone
  s_waitcnt vmcnt(28)
  v_dot2_f32_bf16 v13, v160, v9, 0
  v_dot2_f32_bf16 v14, v164, v9, 0
  v_dot2_f32_bf16 v15, v168, v9, 0
  v_dot2_f32_bf16 v16, v172, v9, 0
  v_dot2_f32_bf16 v13, v161, v10, v13
  v_dot2_f32_bf16 v14, v165, v10, v14
  v_dot2_f32_bf16 v15, v169, v10, v15
  v_dot2_f32_bf16 v16, v173, v10, v16
  v_dot2_f32_bf16 v13, v162, v11, v13
  v_dot2_f32_bf16 v14, v166, v11, v14
  v_dot2_f32_bf16 v15, v170, v11, v15
  v_dot2_f32_bf16 v16, v174, v11, v16
  v_dot2_f32_bf16 v13, v163, v12, v13
  v_dot2_f32_bf16 v14, v167, v12, v14
  v_dot2_f32_bf16 v15, v171, v12, v15
  v_dot2_f32_bf16 v16, v175, v12, v16
  v_add_f32_dpp v13, v13, v13 row_ror:8 row_mask:0xf bank_mask:0xf
  v_add_f32_dpp v14, v14, v14 row_ror:8 row_mask:0xf bank_mask:0xf
  v_add_f32_dpp v15, v15, v15 row_ror:8 row_mask:0xf bank_mask:0xf
  v_add_f32_dpp v16, v16, v16 row_ror:8 row_mask:0xf bank_mask:0xf
  v_add_f32_dpp v13, v13, v13 row_ror:4 row_mask:0xf bank_mask:0xf
  v_add_f32_dpp v14, v14, v14 row_ror:4 row_mask:0xf bank_mask:0xf
  v_add_f32_dpp v15, v15, v15 row_ror:4 row_mask:0xf bank_mask:0xf
  v_add_f32_dpp v16, v16, v16 row_ror:4 row_mask:0xf bank_mask:0xf
  v_add_f32_dpp v13, v13, v13 row_ror:2 row_mask:0xf bank_mask:0xf
  v_add_f32_dpp v14, v14, v14 row_ror:2 row_mask:0xf bank_mask:0xf
  v_add_f32_dpp v15, v15, v15 row_ror:2 row_mask:0xf bank_mask:0xf
  v_add_f32_dpp v16, v16, v16 row_ror:2 row_mask:0xf bank_mask:0xf
  v_add_f32_dpp v13, v13, v13 row_ror:1 row_mask:0xf bank_mask:0xf
  v_add_f32_dpp v14, v14, v14 row_ror:1 row_mask:0xf bank_mask:0xf
  v_add_f32_dpp v15, v15, v15 row_ror:1 row_mask:0xf bank_mask:0xf
  v_add_f32_dpp v16, v16, v16 row_ror:1 row_mask:0xf bank_mask:0xf
  v_cvt_pk_bf16_f32 v17, v13, v14
  v_cvt_pk_bf16_f32 v18, v15, v16
  v_lshlrev_b32 v13, 16, v17
  v_and_b32 v14, 0xffff0000, v17
  v_lshlrev_b32 v15, 16, v18
  v_and_b32 v16, 0xffff0000, v18
  v_mul_f32 v13, s26, v13
  v_mul_f32 v14, s26, v14
  v_mul_f32 v15, s26, v15
  v_mul_f32 v16, s26, v16
  v_cvt_pk_bf16_f32 v17, v13, v14
  v_cvt_pk_bf16_f32 v18, v15, v16
  v_lshlrev_b32 v13, 16, v17
  v_and_b32 v14, 0xffff0000, v17
  v_lshlrev_b32 v15, 16, v18
  v_and_b32 v16, 0xffff0000, v18
  v_max3_f32 v20, v13, v14, v19
  v_max3_f32 v20, v15, v16, v20
  v_mov_b32 v21, v20
  s_nop 1
  v_permlane16_swap_b32 v20, v21
  v_max_f32 v20, v20, v21
  v_mov_b32 v21, v20
  s_nop 1
  v_permlane32_swap_b32 v20, v21
  v_max_f32 v20, v20, v21
  v_sub_f32 v22, v19, v20
  v_mul_f32 v23, 0x3fb8aa3b, v20
  v_mul_f32 v22, 0x3fb8aa3b, v22
  v_mov_b32 v19, v20
  v_exp_f32 v22, v22
  v_mov_b32 v21, 0x3fb8aa3b
  v_fma_f32 v13, v13, v21, -v23
  v_fma_f32 v14, v14, v21, -v23
  v_fma_f32 v15, v15, v21, -v23
  v_fma_f32 v16, v16, v21, -v23
  v_exp_f32 v13, v13
  v_exp_f32 v14, v14
  v_exp_f32 v15, v15
  v_exp_f32 v16, v16
  v_mul_f32 v28, v22, v28
  v_mul_f32 v29, v22, v29
  v_mul_f32 v30, v22, v30
  v_mul_f32 v31, v22, v31
  v_cvt_pk_bf16_f32 v48, v13, v13
  v_cvt_pk_bf16_f32 v49, v14, v14
  v_cvt_pk_bf16_f32 v50, v15, v15
  v_cvt_pk_bf16_f32 v51, v16, v16
  v_add_f32 v17, v13, v14
  v_add_f32 v18, v15, v16
  v_and_b32 v32, v48, v5
  v_and_b32 v33, v48, v6
  v_and_b32 v34, v48, v7
  v_and_b32 v35, v48, v8
  v_and_b32 v36, v49, v5
  v_and_b32 v37, v49, v6
  v_and_b32 v38, v49, v7
  v_and_b32 v39, v49, v8
  v_and_b32 v40, v50, v5
  v_and_b32 v41, v50, v6
  v_and_b32 v42, v50, v7
  v_and_b32 v43, v50, v8
  v_and_b32 v44, v51, v5
  v_and_b32 v45, v51, v6
  v_and_b32 v46, v51, v7
  v_and_b32 v47, v51, v8
  v_add_f32 v17, v17, v18
  v_fma_f32 v24, v24, v22, v17
  s_waitcnt vmcnt(24)
  v_mfma_f32_16x16x32_bf16 v[28:31], v[176:179], v[32:35], v[28:31]
  v_mfma_f32_16x16x32_bf16 v[28:31], v[180:183], v[36:39], v[28:31]
  v_mfma_f32_16x16x32_bf16 v[28:31], v[184:187], v[40:43], v[28:31]
  v_mfma_f32_16x16x32_bf16 v[28:31], v[188:191], v[44:47], v[28:31]
  s_cmp_ge_u32 s72, 0x8000000
  s_cbranch_scc1 L_sdone
  s_waitcnt vmcnt(20)
  v_dot2_f32_bf16 v13, v192, v9, 0
  v_dot2_f32_bf16 v14, v196, v9, 0
  v_dot2_f32_bf16 v15, v200, v9, 0
  v_dot2_f32_bf16 v16, v204, v9, 0
  v_dot2_f32_bf16 v13, v193, v10, v13
  v_dot2_f32_bf16 v14, v197, v10, v14
  v_dot2_f32_bf16 v15, v201, v10, v15
  v_dot2_f32_bf16 v16, v205, v10, v16
  v_dot2_f32_bf16 v13, v194, v11, v13
  v_dot2_f32_bf16 v14, v198, v11, v14
  v_dot2_f32_bf16 v15, v202, v11, v15
  v_dot2_f32_bf16 v16, v206, v11, v16
  v_dot2_f32_bf16 v13, v195, v12, v13
  v_dot2_f32_bf16 v14, v199, v12, v14
  v_dot2_f32_bf16 v15, v203, v12, v15
  v_dot2_f32_bf16 v16, v207, v12, v16
  v_add_f32_dpp v13, v13, v13 row_ror:8 row_mask:0xf bank_mask:0xf
  v_add_f32_dpp v14, v14, v14 row_ror:8 row_mask:0xf bank_mask:0xf
  v_add_f32_dpp v15, v15, v15 row_ror:8 row_mask:0xf bank_mask:0xf
  v_add_f32_dpp v16, v16, v16 row_ror:8 row_mask:0xf bank_mask:0xf
  v_add_f32_dpp v13, v13, v13 row_ror:4 row_mask:0xf bank_mask:0xf
  v_add_f32_dpp v14, v14, v14 row_ror:4 row_mask:0xf bank_mask:0xf
  v_add_f32_dpp v15, v15, v15 row_ror:4 row_mask:0xf bank_mask:0xf
  v_add_f32_dpp v16, v16, v16 row_ror:4 row_mask:0xf bank_mask:0xf
  v_add_f32_dpp v13, v13, v13 row_ror:2 row_mask:0xf bank_mask:0xf
  v_add_f32_dpp v14, v14, v14 row_ror:2 row_mask:0xf bank_mask:0xf
  v_add_f32_dpp v15, v15, v15 row_ror:2 row_mask:0xf bank_mask:0xf
  v_add_f32_dpp v16, v16, v16 row_ror:2 row_mask:0xf bank_mask:0xf
  v_add_f32_dpp v13, v13, v13 row_ror:1 row_mask:0xf bank_mask:0xf
  v_add_f32_dpp v14, v14, v14 row_ror:1 row_mask:0xf bank_mask:0xf
  v_add_f32_dpp v15, v15, v15 row_ror:1 row_mask:0xf bank_mask:0xf
  v_add_f32_dpp v16, v16, v16 row_ror:1 row_mask:0xf bank_mask:0xf
  v_cvt_pk_bf16_f32 v17, v13, v14
  v_cvt_pk_bf16_f32 v18, v15, v16
  v_lshlrev_b32 v13, 16, v17
  v_and_b32 v14, 0xffff0000, v17
  v_lshlrev_b32 v15, 16, v18
  v_and_b32 v16, 0xffff0000, v18
  v_mul_f32 v13, s26, v13
  v_mul_f32 v14, s26, v14
  v_mul_f32 v15, s26, v15
  v_mul_f32 v16, s26, v16
  v_cvt_pk_bf16_f32 v17, v13, v14
  v_cvt_pk_bf16_f32 v18, v15, v16
  v_lshlrev_b32 v13, 16, v17
  v_and_b32 v14, 0xffff0000, v17
  v_lshlrev_b32 v15, 16, v18
  v_and_b32 v16, 0xffff0000, v18
  v_max3_f32 v20, v13, v14, v19
  v_max3_f32 v20, v15, v16, v20
  v_mov_b32 v21, v20
  s_nop 1
  v_permlane16_swap_b32 v20, v21
  v_max_f32 v20, v20, v21
  v_mov_b32 v21, v20
  s_nop 1
  v_permlane32_swap_b32 v20, v21
  v_max_f32 v20, v20, v21
  v_sub_f32 v22, v19, v20
  v_mul_f32 v23, 0x3fb8aa3b, v20
  v_mul_f32 v22, 0x3fb8aa3b, v22
  v_mov_b32 v19, v20
  v_exp_f32 v22, v22
  v_mov_b32 v21, 0x3fb8aa3b
  v_fma_f32 v13, v13, v21, -v23
  v_fma_f32 v14, v14, v21, -v23
  v_fma_f32 v15, v15, v21, -v23
  v_fma_f32 v16, v16, v21, -v23
  v_exp_f32 v13, v13
  v_exp_f32 v14, v14
  v_exp_f32 v15, v15
  v_exp_f32 v16, v16
  v_mul_f32 v28, v22, v28
  v_mul_f32 v29, v22, v29
  v_mul_f32 v30, v22, v30
  v_mul_f32 v31, v22, v31
  v_cvt_pk_bf16_f32 v48, v13, v13
  v_cvt_pk_bf16_f32 v49, v14, v14
  v_cvt_pk_bf16_f32 v50, v15, v15
  v_cvt_pk_bf16_f32 v51, v16, v16
  v_add_f32 v17, v13, v14
  v_add_f32 v18, v15, v16
  v_and_b32 v32, v48, v5
  v_and_b32 v33, v48, v6
  v_and_b32 v34, v48, v7
  v_and_b32 v35, v48, v8
  v_and_b32 v36, v49, v5
  v_and_b32 v37, v49, v6
  v_and_b32 v38, v49, v7
  v_and_b32 v39, v49, v8
  v_and_b32 v40, v50, v5
  v_and_b32 v41, v50, v6
  v_and_b32 v42, v50, v7
  v_and_b32 v43, v50, v8
  v_and_b32 v44, v51, v5
  v_and_b32 v45, v51, v6
  v_and_b32 v46, v51, v7
  v_and_b32 v47, v51, v8
  v_add_f32 v17, v17, v18
  v_fma_f32 v24, v24, v22, v17
  s_waitcnt vmcnt(16)
  v_mfma_f32_16x16x32_bf16 v[28:31], v[208:211], v[32:35], v[28:31]
  v_mfma_f32_16x16x32_bf16 v[28:31], v[212:215], v[36:39], v[28:31]
  v_mfma_f32_16x16x32_bf16 v[28:31], v[216:219], v[40:43], v[28:31]
  v_mfma_f32_16x16x32_bf16 v[28:31], v[220:223], v[44:47], v[28:31]
L_loop2:
  s_cmp_ge_u32 s68, 0x8000000
  s_cbranch_scc1 L_sdone
  s_waitcnt vmcnt(12)
  v_dot2_f32_bf16 v13, v64, v9, 0
  v_dot2_f32_bf16 v14, v68, v9, 0
  v_dot2_f32_bf16 v15, v72, v9, 0
  v_dot2_f32_bf16 v16, v76, v9, 0
  v_dot2_f32_bf16 v13, v65, v10, v13
  v_dot2_f32_bf16 v14, v69, v10, v14
  v_dot2_f32_bf16 v15, v73, v10, v15
  v_dot2_f32_bf16 v16, v77, v10, v16
  v_dot2_f32_bf16 v13, v66, v11, v13
  v_dot2_f32_bf16 v14, v70, v11, v14
  v_dot2_f32_bf16 v15, v74, v11, v15
  v_dot2_f32_bf16 v16, v78, v11, v16
  v_dot2_f32_bf16 v13, v67, v12, v13
  v_dot2_f32_bf16 v14, v71, v12, v14
  v_dot2_f32_bf16 v15, v75, v12, v15
  v_dot2_f32_bf16 v16, v79, v12, v16
  v_readfirstlane_b32 s24, v52
  s_mov_b64 exec, 1
  s_or_b32 s24, s24, s74
  s_cmp_ge_u32 s24, s64
  s_cselect_b32 s74, 512, 0
  s_cselect_b32 s25, 0, 1
  v_mov_b32 v52, s25
  s_add_u32 s25, s24, s80
  s_and_b32 s25, s25, 511
  s_lshl_b32 s25, s25, 12
  s_add_u32 s25, s25, s66
  s_cmp_lt_u32 s24, 512
  s_cselect_b32 s68, s25, 0x8000000
  buffer_atomic_add v52, off, s[16:19], s84 sc0 sc1
  s_mov_b64 exec, -1
  buffer_load_dwordx4 v[64:67], v2, s[8:11], s68 offen offset:0 nt
  buffer_load_dwordx4 v[68:71], v2, s[8:11], s68 offen offset:1024 nt
  buffer_load_dwordx4 v[72:75], v2, s[8:11], s68 offen offset:2048 nt
  buffer_load_dwordx4 v[76:79], v2, s[8:11], s68 offen offset:3072 nt
  v_add_f32_dpp v13, v13, v13 row_ror:8 row_mask:0xf bank_mask:0xf
  v_add_f32_dpp v14, v14, v14 row_ror:8 row_mask:0xf bank_mask:0xf
  v_add_f32_dpp v15, v15, v15 row_ror:8 row_mask:0xf bank_mask:0xf
  v_add_f32_dpp v16, v16, v16 row_ror:8 row_mask:0xf bank_mask:0xf
  v_add_f32_dpp v13, v13, v13 row_ror:4 row_mask:0xf bank_mask:0xf
  v_add_f32_dpp v14, v14, v14 row_ror:4 row_mask:0xf bank_mask:0xf
  v_add_f32_dpp v15, v15, v15 row_ror:4 row_mask:0xf bank_mask:0xf
  v_add_f32_dpp v16, v16, v16 row_ror:4 row_mask:0xf bank_mask:0xf
  v_add_f32_dpp v13, v13, v13 row_ror:2 row_mask:0xf bank_mask:0xf
  v_add_f32_dpp v14, v14, v14 row_ror:2 row_mask:0xf bank_mask:0xf
  v_add_f32_dpp v15, v15, v15 row_ror:2 row_mask:0xf bank_mask:0xf
  v_add_f32_dpp v16, v16, v16 row_ror:2 row_mask:0xf bank_mask:0xf
  v_add_f32_dpp v13, v13, v13 row_ror:1 row_mask:0xf bank_mask:0xf
  v_add_f32_dpp v14, v14, v14 row_ror:1 row_mask:0xf bank_mask:0xf
  v_add_f32_dpp v15, v15, v15 row_ror:1 row_mask:0xf bank_mask:0xf
  v_add_f32_dpp v16, v16, v16 row_ror:1 row_mask:0xf bank_mask:0xf
  v_cvt_pk_bf16_f32 v17, v13, v14
  v_cvt_pk_bf16_f32 v18, v15, v16
  v_lshlrev_b32 v13, 16, v17
  v_and_b32 v14, 0xffff0000, v17
  v_lshlrev_b32 v15, 16, v18
  v_and_b32 v16, 0xffff0000, v18
  v_mul_f32 v13, s26, v13
  v_mul_f32 v14, s26, v14
  v_mul_f32 v15, s26, v15
  v_mul_f32 v16, s26, v16
  v_cvt_pk_bf16_f32 v17, v13, v14
  v_cvt_pk_bf16_f32 v18, v15, v16
  v_lshlrev_b32 v13, 16, v17
  v_and_b32 v14, 0xffff0000, v17
  v_lshlrev_b32 v15, 16, v18
  v_and_b32 v16, 0xffff0000, v18
  v_max3_f32 v20, v13, v14, v19
  v_max3_f32 v20, v15, v16, v20
  v_mov_b32 v21, v20
  s_nop 1
  v_permlane16_swap_b32 v20, v21
  v_max_f32 v20, v20, v21
  v_mov_b32 v21, v20
  s_nop 1
  v_permlane32_swap_b32 v20, v21
  v_max_f32 v20, v20, v21
  v_sub_f32 v22, v19, v20
  v_mul_f32 v23, 0x3fb8aa3b, v20
  v_mul_f32 v22, 0x3fb8aa3b, v22
  v_mov_b32 v19, v20
  v_exp_f32 v22, v22
  v_mov_b32 v21, 0x3fb8aa3b
  v_fma_f32 v13, v13, v21, -v23
  v_fma_f32 v14, v14, v21, -v23
  v_fma_f32 v15, v15, v21, -v23
  v_fma_f32 v16, v16, v21, -v23
  v_exp_f32 v13, v13
  v_exp_f32 v14, v14
  v_exp_f32 v15, v15
  v_exp_f32 v16, v16
  v_mul_f32 v28, v22, v28
  v_mul_f32 v29, v22, v29
  v_mul_f32 v30, v22, v30
  v_mul_f32 v31, v22, v31
  v_cvt_pk_bf16_f32 v48, v13, v13
  v_cvt_pk_bf16_f32 v49, v14, v14
  v_cvt_pk_bf16_f32 v50, v15, v15
  v_cvt_pk_bf16_f32 v51, v16, v16
  v_add_f32 v17, v13, v14
  v_add_f32 v18, v15, v16
  v_and_b32 v32, v48, v5
  v_and_b32 v33, v48, v6
  v_and_b32 v34, v48, v7
  v_and_b32 v35, v48, v8
  v_and_b32 v36, v49, v5
  v_and_b32 v37, v49, v6
  v_and_b32 v38, v49, v7
  v_and_b32 v39, v49, v8
  v_and_b32 v40, v50, v5
  v_and_b32 v41, v50, v6
  v_and_b32 v42, v50, v7
  v_and_b32 v43, v50, v8
  v_and_b32 v44, v51, v5
  v_and_b32 v45, v51, v6
  v_and_b32 v46, v51, v7
  v_and_b32 v47, v51, v8
  v_add_f32 v17, v17, v18
  v_fma_f32 v24, v24, v22, v17
  s_waitcnt vmcnt(13)
  v_mfma_f32_16x16x32_bf16 v[28:31], v[80:83], v[32:35], v[28:31]
  v_mfma_f32_16x16x32_bf16 v[28:31], v[84:87], v[36:39], v[28:31]
  v_mfma_f32_16x16x32_bf16 v[28:31], v[88:91], v[40:43], v[28:31]
  v_mfma_f32_16x16x32_bf16 v[28:31], v[92:95], v[44:47], v[28:31]
  buffer_load_dwordx4 v[80:83], v2, s[12:15], s68 offen offset:0 nt
  buffer_load_dwordx4 v[84:87], v2, s[12:15], s68 offen offset:1024 nt
  buffer_load_dwordx4 v[88:91], v2, s[12:15], s68 offen offset:2048 nt
  buffer_load_dwordx4 v[92:95], v2, s[12:15], s68 offen offset:3072 nt
  s_cmp_ge_u32 s69, 0x8000000
  s_cbranch_scc1 L_sdone
  s_waitcnt vmcnt(12)
  v_dot2_f32_bf16 v13, v96, v9, 0
  v_dot2_f32_bf16 v14, v100, v9, 0
  v_dot2_f32_bf16 v15, v104, v9, 0
  v_dot2_f32_bf16 v16, v108, v9, 0
  v_dot2_f32_bf16 v13, v97, v10, v13
  v_dot2_f32_bf16 v14, v101, v10, v14
  v_dot2_f32_bf16 v15, v105, v10, v15
  v_dot2_f32_bf16 v16, v109, v10, v16
  v_dot2_f32_bf16 v13, v98, v11, v13
  v_dot2_f32_bf16 v14, v102, v11, v14
  v_dot2_f32_bf16 v15, v106, v11, v15
  v_dot2_f32_bf16 v16, v110, v11, v16
  v_dot2_f32_bf16 v13, v99, v12, v13
  v_dot2_f32_bf16 v14, v103, v12, v14
  v_dot2_f32_bf16 v15, v107, v12, v15
  v_dot2_f32_bf16 v16, v111, v12, v16
  v_readfirstlane_b32 s24, v53
  s_mov_b64 exec, 1
  s_or_b32 s24, s24, s75
  s_cmp_ge_u32 s24, s64
  s_cselect_b32 s75, 512, 0
  s_cselect_b32 s25, 0, 1
  v_mov_b32 v53, s25
  s_add_u32 s25, s24, s80
  s_and_b32 s25, s25, 511
  s_lshl_b32 s25, s25, 12
  s_add_u32 s25, s25, s66
  s_cmp_lt_u32 s24, 512
  s_cselect_b32 s69, s25, 0x8000000
  buffer_atomic_add v53, off, s[16:19], s84 sc0 sc1
  s_mov_b64 exec, -1
  buffer_load_dwordx4 v[96:99], v2, s[8:11], s69 offen offset:0 nt
  buffer_load_dwordx4 v[100:103], v2, s[8:11], s69 offen offset:1024 nt
  buffer_load_dwordx4 v[104:107], v2, s[8:11], s69 offen offset:2048 nt
  buffer_load_dwordx4 v[108:111], v2, s[8:11], s69 offen offset:3072 nt
  v_add_f32_dpp v13, v13, v13 row_ror:8 row_mask:0xf bank_mask:0xf
  v_add_f32_dpp v14, v14, v14 row_ror:8 row_mask:0xf bank_mask:0xf
  v_add_f32_dpp v15, v15, v15 row_ror:8 row_mask:0xf bank_mask:0xf
  v_add_f32_dpp v16, v16, v16 row_ror:8 row_mask:0xf bank_mask:0xf
  v_add_f32_dpp v13, v13, v13 row_ror:4 row_mask:0xf bank_mask:0xf
  v_add_f32_dpp v14, v14, v14 row_ror:4 row_mask:0xf bank_mask:0xf
  v_add_f32_dpp v15, v15, v15 row_ror:4 row_mask:0xf bank_mask:0xf
  v_add_f32_dpp v16, v16, v16 row_ror:4 row_mask:0xf bank_mask:0xf
  v_add_f32_dpp v13, v13, v13 row_ror:2 row_mask:0xf bank_mask:0xf
  v_add_f32_dpp v14, v14, v14 row_ror:2 row_mask:0xf bank_mask:0xf
  v_add_f32_dpp v15, v15, v15 row_ror:2 row_mask:0xf bank_mask:0xf
  v_add_f32_dpp v16, v16, v16 row_ror:2 row_mask:0xf bank_mask:0xf
  v_add_f32_dpp v13, v13, v13 row_ror:1 row_mask:0xf bank_mask:0xf
  v_add_f32_dpp v14, v14, v14 row_ror:1 row_mask:0xf bank_mask:0xf
  v_add_f32_dpp v15, v15, v15 row_ror:1 row_mask:0xf bank_mask:0xf
  v_add_f32_dpp v16, v16, v16 row_ror:1 row_mask:0xf bank_mask:0xf
  v_cvt_pk_bf16_f32 v17, v13, v14
  v_cvt_pk_bf16_f32 v18, v15, v16
  v_lshlrev_b32 v13, 16, v17
  v_and_b32 v14, 0xffff0000, v17
  v_lshlrev_b32 v15, 16, v18
  v_and_b32 v16, 0xffff0000, v18
  v_mul_f32 v13, s26, v13
  v_mul_f32 v14, s26, v14
  v_mul_f32 v15, s26, v15
  v_mul_f32 v16, s26, v16
  v_cvt_pk_bf16_f32 v17, v13, v14
  v_cvt_pk_bf16_f32 v18, v15, v16
  v_lshlrev_b32 v13, 16, v17
  v_and_b32 v14, 0xffff0000, v17
  v_lshlrev_b32 v15, 16, v18
  v_and_b32 v16, 0xffff0000, v18
  v_max3_f32 v20, v13, v14, v19
  v_max3_f32 v20, v15, v16, v20
  v_mov_b32 v21, v20
  s_nop 1
  v_permlane16_swap_b32 v20, v21
  v_max_f32 v20, v20, v21
  v_mov_b32 v21, v20
  s_nop 1
  v_permlane32_swap_b32 v20, v21
  v_max_f32 v20, v20, v21
  v_sub_f32 v22, v19, v20
  v_mul_f32 v23, 0x3fb8aa3b, v20
  v_mul_f32 v22, 0x3fb8aa3b, v22
  v_mov_b32 v19, v20
  v_exp_f32 v22, v22
  v_mov_b32 v21, 0x3fb8aa3b
  v_fma_f32 v13, v13, v21, -v23
  v_fma_f32 v14, v14, v21, -v23
  v_fma_f32 v15, v15, v21, -v23
  v_fma_f32 v16, v16, v21, -v23
  v_exp_f32 v13, v13
  v_exp_f32 v14, v14
  v_exp_f32 v15, v15
  v_exp_f32 v16, v16
  v_mul_f32 v28, v22, v28
  v_mul_f32 v29, v22, v29
  v_mul_f32 v30, v22, v30
  v_mul_f32 v31, v22, v31
  v_cvt_pk_bf16_f32 v48, v13, v13
  v_cvt_pk_bf16_f32 v49, v14, v14
  v_cvt_pk_bf16_f32 v50, v15, v15
  v_cvt_pk_bf16_f32 v51, v16, v16
  v_add_f32 v17, v13, v14
  v_add_f32 v18, v15, v16
  v_and_b32 v32, v48, v5
  v_and_b32 v33, v48, v6
  v_and_b32 v34, v48, v7
  v_and_b32 v35, v48, v8
  v_and_b32 v36, v49, v5
  v_and_b32 v37, v49, v6
  v_and_b32 v38, v49, v7
  v_and_b32 v39, v49, v8
  v_and_b32 v40, v50, v5
  v_and_b32 v41, v50, v6
  v_and_b32 v42, v50, v7
  v_and_b32 v43, v50, v8
  v_and_b32 v44, v51, v5
  v_and_b32 v45, v51, v6
  v_and_b32 v46, v51, v7
  v_and_b32 v47, v51, v8
  v_add_f32 v17, v17, v18
  v_fma_f32 v24, v24, v22, v17
  s_waitcnt vmcnt(13)
  v_mfma_f32_16x16x32_bf16 v[28:31], v[112:115], v[32:35], v[28:31]
  v_mfma_f32_16x16x32_bf16 v[28:31], v[116:119], v[36:39], v[28:31]
  v_mfma_f32_16x16x32_bf16 v[28:31], v[120:123], v[40:43], v[28:31]
  v_mfma_f32_16x16x32_bf16 v[28:31], v[124:127], v[44:47], v[28:31]
  buffer_load_dwordx4 v[112:115], v2, s[12:15], s69 offen offset:0 nt
  buffer_load_dwordx4 v[116:119], v2, s[12:15], s69 offen offset:1024 nt
  buffer_load_dwordx4 v[120:123], v2, s[12:15], s69 offen offset:2048 nt
  buffer_load_dwordx4 v[124:127], v2, s[12:15], s69 offen offset:3072 nt
  s_branch L_loop2
L_sdone:
  v_mov_b32 v21, v24
  s_nop 1
  v_permlane16_swap_b32 v24, v21
  v_add_f32 v24, v24, v21
  v_mov_b32 v21, v24
  s_nop 1
  v_permlane32_swap_b32 v24, v21
  v_add_f32 v24, v24, v21
  s_mul_i32 s27, s87, 2560
  s_add_u32 s27, s27, 147968
  v_lshlrev_b32 v21, 7, v3
  v_lshl_add_u32 v21, v1, 4, v21
  v_add_u32 v21, s27, v21
  s_mul_i32 s24, s63, 640
  v_add_u32 v22, s24, v21
  s_add_u32 s24, s24, s27
  v_mov_b32 v23, s24
  v_mov_b32 v25, v24
  v_mov_b32 v24, v19
  s_mov_b32 exec_lo, 0x00ff00ff
  s_mov_b32 exec_hi, 0x00ff00ff
  ds_write_b128 v22, v[28:31]
  ds_write_b64 v23, v[24:25] offset:512
  s_cmp_eq_u32 s85, 1
  s_cbranch_scc1 L_snn
  v_mov_b32 v32, 0
  v_mov_b32 v33, 0
  v_mov_b32 v34, 0
  v_mov_b32 v35, 0
  v_mov_b32 v36, 0xf149f2ca
  v_mov_b32 v37, 0
  ds_write_b128 v22, v[32:35] offset:1280
  ds_write_b64 v23, v[36:37] offset:1792
L_snn:
  s_mov_b64 exec, 1
  s_lshl_b32 s24, s87, 2
  s_add_u32 s24, s24, 153120
  v_mov_b32 v22, s24
  v_mov_b32 v23, s85
  s_waitcnt lgkmcnt(0)
  ds_add_rtn_u32 v23, v22, v23
  s_waitcnt lgkmcnt(0)
  s_mov_b64 exec, -1
  v_readfirstlane_b32 s24, v23
  s_add_u32 s24, s24, s85
  s_cmp_lg_u32 s24, 4
  s_cbranch_scc1 L_sfin
  s_add_u32 s27, s27, 512
  v_mov_b32 v22, s27
  s_waitcnt vmcnt(0)
  ds_read_b64 v[96:97], v22 offset:0
  ds_read_b64 v[98:99], v22 offset:640
  ds_read_b64 v[100:101], v22 offset:1280
  ds_read_b64 v[102:103], v22 offset:1920
  ds_read_b128 v[64:67], v21 offset:0
  ds_read_b128 v[68:71], v21 offset:640
  ds_read_b128 v[72:75], v21 offset:1280
  ds_read_b128 v[76:79], v21 offset:1920
  s_and_b32 s24, s62, 31
  s_lshl_b32 s24, s24, 14
  s_add_u32 s24, s24, 1310720
  s_lshr_b32 s25, s62, 5
  s_lshl_b32 s25, s25, 2
  s_add_u32 s25, s25, s6
  s_lshr_b32 s27, s62, 5
  s_add_u32 s27, s27, 8
  s_cmp_eq_u32 s6, 4
  s_cselect_b32 s25, s27, s25
  s_cselect_b32 s30, 256, 0
  s_lshl_b32 s27, s25, 4
  s_add_u32 s27, s27, s24
  s_lshl_b32 s25, s25, 8
  s_add_u32 s24, s24, s25
  s_add_u32 s24, s24, s30
  v_lshlrev_b32 v44, 12, v3
  v_lshl_add_u32 v44, v4, 5, v44
  v_lshlrev_b32 v45, 12, v0
  v_mov_b32 v33, s7
  v_mov_b32 v35, s7
  v_mov_b32 v37, s7
  v_mov_b32 v39, s7
  v_mov_b32 v41, s7
  v_mov_b32 v43, s7
  s_waitcnt lgkmcnt(4)
  v_mov_b32 v40, v96
  v_max_f32 v40, v40, v98
  v_max_f32 v40, v40, v100
  v_max_f32 v40, v40, v102
  v_sub_f32 v96, v96, v40
  v_sub_f32 v98, v98, v40
  v_sub_f32 v100, v100, v40
  v_sub_f32 v102, v102, v40
  v_mul_f32 v96, 0x3fb8aa3b, v96
  v_mul_f32 v98, 0x3fb8aa3b, v98
  v_mul_f32 v100, 0x3fb8aa3b, v100
  v_mul_f32 v102, 0x3fb8aa3b, v102
  v_exp_f32 v96, v96
  v_exp_f32 v98, v98
  v_exp_f32 v100, v100
  v_exp_f32 v102, v102
  v_mul_f32 v42, v96, v97
  v_fma_f32 v42, v98, v99, v42
  v_fma_f32 v42, v100, v101, v42
  v_fma_f32 v42, v102, v103, v42
  s_waitcnt lgkmcnt(0)
  v_mul_f32 v32, v96, v64
  v_mul_f32 v34, v96, v65
  v_mul_f32 v36, v96, v66
  v_mul_f32 v38, v96, v67
  v_fma_f32 v32, v98, v68, v32
  v_fma_f32 v34, v98, v69, v34
  v_fma_f32 v36, v98, v70, v36
  v_fma_f32 v38, v98, v71, v38
  v_fma_f32 v32, v100, v72, v32
  v_fma_f32 v34, v100, v73, v34
  v_fma_f32 v36, v100, v74, v36
  v_fma_f32 v38, v100, v75, v38
  v_fma_f32 v32, v102, v76, v32
  v_fma_f32 v34, v102, v77, v34
  v_fma_f32 v36, v102, v78, v36
  v_fma_f32 v38, v102, v79, v38
  s_mov_b32 exec_lo, 0x00ff00ff
  s_mov_b32 exec_hi, 0x00ff00ff
  buffer_store_dwordx4 v[32:35], v44, s[16:19], s24 offen sc1
  buffer_store_dwordx4 v[36:39], v44, s[16:19], s24 offen offset:16 sc1
  s_mov_b64 exec, 15
  buffer_store_dwordx4 v[40:43], v45, s[16:19], s27 offen offset:2048 sc1
  s_mov_b64 exec, -1
L_sfin:
  s_cmp_eq_u32 s6, 4
  s_cbranch_scc1 L_setb2
  s_branch L_fin
L_sexit:
  s_barrier
  s_branch L_fin
L_bwg:
  s_mov_b32 s20, s32
  s_mov_b32 s21, s33
  s_mov_b32 s22, 0x800
  s_mov_b32 s23, 0x20000
  s_and_b32 s5, s2, 31
  s_lshl_b32 s65, s5, 8
  v_lshrrev_b32 v7, 3, v4
  v_lshlrev_b32 v28, 10, v7
  v_lshlrev_b32 v7, 8, v7
  v_lshl_add_u32 v7, v3, 6, v7
  s_lshl_b32 s86, s5, 17
  s_lshl_b32 s24, s63, 8
  s_add_u32 s86, s86, s24
  s_cmp_ge_u32 s2, 32
  s_cbranch_scc1 L_wwg
  s_mov_b32 s8, s38
  s_mov_b32 s9, s39
  s_mov_b32 s10, 0x400000
  s_mov_b32 s11, 0x20000
  s_lshl_b32 s64, s3, 19
  s_add_u32 s64, s64, s65
  s_lshl_b32 s27, s3, 7
  v_lshlrev_b32 v5, 17, v3
  v_lshl_add_u32 v5, v4, 4, v5
  v_lshl_add_u32 v28, v3, 5, v28
  s_and_b32 s80, s2, 1
  s_lshl_b32 s79, s80, 16
  s_lshl_b32 s80, s80, 4
  s_cmp_lg_u32 s3, 0
  s_cbranch_scc1 L_noti
  s_add_u32 s24, s65, 1093632
  v_lshlrev_b32 v29, 13, v0
  v_mov_b32 v30, 392
  s_mov_b64 exec, 3
  buffer_store_dword v30, v29, s[16:19], s24 offen sc0 sc1
  s_mov_b64 exec, -1
L_noti:
  s_add_u32 s24, s80, 0
  s_and_b32 s24, s24, 31
  s_add_u32 s24, s24, s27
  buffer_load_dwordx4 v[112:115], v28, s[20:23], s24 offen
  s_add_u32 s24, s80, 16
  s_and_b32 s24, s24, 31
  s_add_u32 s24, s24, s27
  buffer_load_dwordx4 v[116:119], v28, s[20:23], s24 offen
  s_mov_b32 s25, s79
  s_add_u32 s24, s64, s25
  buffer_load_dwordx4 v[128:131], v5, s[8:11], s24 offen nt
  s_add_u32 s25, s25, 8192
  s_and_b32 s25, s25, 0x1ffff
  s_add_u32 s24, s64, s25
  buffer_load_dwordx4 v[132:135], v5, s[8:11], s24 offen nt
  s_add_u32 s25, s25, 8192
  s_and_b32 s25, s25, 0x1ffff
  s_add_u32 s24, s64, s25
  buffer_load_dwordx4 v[136:139], v5, s[8:11], s24 offen nt
  s_add_u32 s25, s25, 8192
  s_and_b32 s25, s25, 0x1ffff
  s_add_u32 s24, s64, s25
  buffer_load_dwordx4 v[140:143], v5, s[8:11], s24 offen nt
  s_add_u32 s25, s25, 8192
  s_and_b32 s25, s25, 0x1ffff
  s_add_u32 s24, s64, s25
  buffer_load_dwordx4 v[144:147], v5, s[8:11], s24 offen nt
  s_add_u32 s25, s25, 8192
  s_and_b32 s25, s25, 0x1ffff
  s_add_u32 s24, s64, s25
  buffer_load_dwordx4 v[148:151], v5, s[8:11], s24 offen nt
  s_add_u32 s25, s25, 8192
  s_and_b32 s25, s25, 0x1ffff
  s_add_u32 s24, s64, s25
  buffer_load_dwordx4 v[152:155], v5, s[8:11], s24 offen nt
  s_add_u32 s25, s25, 8192
  s_and_b32 s25, s25, 0x1ffff
  s_add_u32 s24, s64, s25
  buffer_load_dwordx4 v[156:159], v5, s[8:11], s24 offen nt
  s_add_u32 s25, s25, 8192
  s_and_b32 s25, s25, 0x1ffff
  s_add_u32 s24, s64, s25
  buffer_load_dwordx4 v[160:163], v5, s[8:11], s24 offen nt
  s_add_u32 s25, s25, 8192
  s_and_b32 s25, s25, 0x1ffff
  s_add_u32 s24, s64, s25
  buffer_load_dwordx4 v[164:167], v5, s[8:11], s24 offen nt
  s_add_u32 s25, s25, 8192
  s_and_b32 s25, s25, 0x1ffff
  s_add_u32 s24, s64, s25
  buffer_load_dwordx4 v[168:171], v5, s[8:11], s24 offen nt
  s_add_u32 s25, s25, 8192
  s_and_b32 s25, s25, 0x1ffff
  s_add_u32 s24, s64, s25
  buffer_load_dwordx4 v[172:175], v5, s[8:11], s24 offen nt
  s_add_u32 s25, s25, 8192
  s_and_b32 s25, s25, 0x1ffff
  s_add_u32 s24, s64, s25
  buffer_load_dwordx4 v[176:179], v5, s[8:11], s24 offen nt
  s_add_u32 s25, s25, 8192
  s_and_b32 s25, s25, 0x1ffff
  s_add_u32 s24, s64, s25
  buffer_load_dwordx4 v[180:183], v5, s[8:11], s24 offen nt
  s_add_u32 s25, s25, 8192
  s_and_b32 s25, s25, 0x1ffff
  s_add_u32 s24, s64, s25
  buffer_load_dwordx4 v[184:187], v5, s[8:11], s24 offen nt
  s_add_u32 s25, s25, 8192
  s_and_b32 s25, s25, 0x1ffff
  s_add_u32 s24, s64, s25
  buffer_load_dwordx4 v[188:191], v5, s[8:11], s24 offen nt
  s_cmp_lg_u32 s3, 0
  s_cbranch_scc1 L_noz1
  v_mov_b32 v28, 153088
  v_lshl_add_u32 v28, v4, 2, v28
  v_mov_b32 v29, 0
  ds_write_b32 v28, v29
L_noz1:
  v_and_b32 v28, 1, v1
  v_lshlrev_b32 v28, 4, v28
  v_mov_b32 v29, 0xffff
  v_lshlrev_b32 v28, v28, v29
  v_lshrrev_b32 v29, 1, v1
  v_cmp_eq_u32 vcc, 0, v29
  s_nop 1
  v_cndmask_b32 v16, 0, v28, vcc
  v_cmp_eq_u32 vcc, 1, v29
  s_nop 1
  v_cndmask_b32 v17, 0, v28, vcc
  v_cmp_eq_u32 vcc, 2, v29
  s_nop 1
  v_cndmask_b32 v18, 0, v28, vcc
  v_cmp_eq_u32 vcc, 3, v29
  s_nop 1
  v_cndmask_b32 v19, 0, v28, vcc
  v_mov_b32 v28, 0x0c0c0c0c
  s_mov_b32 s24, 0x01000100
  s_mov_b32 s25, 0x03020302
  v_bfi_b32 v8, v16, s24, v28
  v_bfi_b32 v12, v16, s25, v28
  v_bfi_b32 v9, v17, s24, v28
  v_bfi_b32 v13, v17, s25, v28
  v_bfi_b32 v10, v18, s24, v28
  v_bfi_b32 v14, v18, s25, v28
  v_bfi_b32 v11, v19, s24, v28
  v_bfi_b32 v15, v19, s25, v28
  s_waitcnt vmcnt(12)
  v_perm_b32 v16, v112, v112, v8
  v_perm_b32 v17, v112, v112, v9
  v_perm_b32 v18, v112, v112, v10
  v_perm_b32 v19, v112, v112, v11
  s_nop 1
  v_mfma_f32_16x16x32_bf16 v[24:27], v[128:131], v[16:19], 0
  v_perm_b32 v20, v112, v112, v12
  v_perm_b32 v21, v112, v112, v13
  v_perm_b32 v22, v112, v112, v14
  v_perm_b32 v23, v112, v112, v15
  s_nop 1
  v_mfma_f32_16x16x32_bf16 v[24:27], v[132:135], v[20:23], v[24:27]
  v_perm_b32 v16, v113, v113, v8
  v_perm_b32 v17, v113, v113, v9
  v_perm_b32 v18, v113, v113, v10
  v_perm_b32 v19, v113, v113, v11
  s_nop 1
  v_mfma_f32_16x16x32_bf16 v[24:27], v[136:139], v[16:19], v[24:27]
  v_perm_b32 v20, v113, v113, v12
  v_perm_b32 v21, v113, v113, v13
  v_perm_b32 v22, v113, v113, v14
  v_perm_b32 v23, v113, v113, v15
  s_nop 1
  v_mfma_f32_16x16x32_bf16 v[24:27], v[140:143], v[20:23], v[24:27]
  s_waitcnt vmcnt(8)
  v_perm_b32 v16, v114, v114, v8
  v_perm_b32 v17, v114, v114, v9
  v_perm_b32 v18, v114, v114, v10
  v_perm_b32 v19, v114, v114, v11
  s_nop 1
  v_mfma_f32_16x16x32_bf16 v[24:27], v[144:147], v[16:19], v[24:27]
  v_perm_b32 v20, v114, v114, v12
  v_perm_b32 v21, v114, v114, v13
  v_perm_b32 v22, v114, v114, v14
  v_perm_b32 v23, v114, v114, v15
  s_nop 1
  v_mfma_f32_16x16x32_bf16 v[24:27], v[148:151], v[20:23], v[24:27]
  v_perm_b32 v16, v115, v115, v8
  v_perm_b32 v17, v115, v115, v9
  v_perm_b32 v18, v115, v115, v10
  v_perm_b32 v19, v115, v115, v11
  s_nop 1
  v_mfma_f32_16x16x32_bf16 v[24:27], v[152:155], v[16:19], v[24:27]
  v_perm_b32 v20, v115, v115, v12
  v_perm_b32 v21, v115, v115, v13
  v_perm_b32 v22, v115, v115, v14
  v_perm_b32 v23, v115, v115, v15
  s_nop 1
  v_mfma_f32_16x16x32_bf16 v[24:27], v[156:159], v[20:23], v[24:27]
  s_waitcnt vmcnt(4)
  v_perm_b32 v16, v116, v116, v8
  v_perm_b32 v17, v116, v116, v9
  v_perm_b32 v18, v116, v116, v10
  v_perm_b32 v19, v116, v116, v11
  s_nop 1
  v_mfma_f32_16x16x32_bf16 v[24:27], v[160:163], v[16:19], v[24:27]
  v_perm_b32 v20, v116, v116, v12
  v_perm_b32 v21, v116, v116, v13
  v_perm_b32 v22, v116, v116, v14
  v_perm_b32 v23, v116, v116, v15
  s_nop 1
  v_mfma_f32_16x16x32_bf16 v[24:27], v[164:167], v[20:23], v[24:27]
  v_perm_b32 v16, v117, v117, v8
  v_perm_b32 v17, v117, v117, v9
  v_perm_b32 v18, v117, v117, v10
  v_perm_b32 v19, v117, v117, v11
  s_nop 1
  v_mfma_f32_16x16x32_bf16 v[24:27], v[168:171], v[16:19], v[24:27]
  v_perm_b32 v20, v117, v117, v12
  v_perm_b32 v21, v117, v117, v13
  v_perm_b32 v22, v117, v117, v14
  v_perm_b32 v23, v117, v117, v15
  s_nop 1
  v_mfma_f32_16x16x32_bf16 v[24:27], v[172:175], v[20:23], v[24:27]
  s_waitcnt vmcnt(0)
  v_perm_b32 v16, v118, v118, v8
  v_perm_b32 v17, v118, v118, v9
  v_perm_b32 v18, v118, v118, v10
  v_perm_b32 v19, v118, v118, v11
  s_nop 1
  v_mfma_f32_16x16x32_bf16 v[24:27], v[176:179], v[16:19], v[24:27]
  v_perm_b32 v20, v118, v118, v12
  v_perm_b32 v21, v118, v118, v13
  v_perm_b32 v22, v118, v118, v14
  v_perm_b32 v23, v118, v118, v15
  s_nop 1
  v_mfma_f32_16x16x32_bf16 v[24:27], v[180:183], v[20:23], v[24:27]
  v_perm_b32 v16, v119, v119, v8
  v_perm_b32 v17, v119, v119, v9
  v_perm_b32 v18, v119, v119, v10
  v_perm_b32 v19, v119, v119, v11
  s_nop 1
  v_mfma_f32_16x16x32_bf16 v[24:27], v[184:187], v[16:19], v[24:27]
  v_perm_b32 v20, v119, v119, v12
  v_perm_b32 v21, v119, v119, v13
  v_perm_b32 v22, v119, v119, v14
  v_perm_b32 v23, v119, v119, v15
  s_nop 1
  v_mfma_f32_16x16x32_bf16 v[24:27], v[188:191], v[20:23], v[24:27]
  v_lshlrev_b32 v30, 1, v7
  v_lshl_add_u32 v30, v1, 2, v30
  s_lshl_b32 s24, s3, 10
  s_add_u32 s24, s24, 135168
  v_add_u32 v30, s24, v30
  s_nop 2
  ds_write_b32 v30, v24 offset:0
  ds_write_b32 v30, v25 offset:32
  ds_write_b32 v30, v26 offset:64
  ds_write_b32 v30, v27 offset:96
  s_waitcnt lgkmcnt(0)
  s_barrier
  s_add_u32 s7, s7, 0x9e3779b1
  s_cmp_lg_u32 s3, 0
  s_cbranch_scc1 L_cq
  v_add_u32 v30, 135168, v2
  ds_read_b128 v[32:35], v30 offset:0
  ds_read_b128 v[36:39], v30 offset:1024
  ds_read_b128 v[40:43], v30 offset:2048
  ds_read_b128 v[44:47], v30 offset:3072
  ds_read_b128 v[48:51], v30 offset:4096
  ds_read_b128 v[52:55], v30 offset:5120
  ds_read_b128 v[56:59], v30 offset:6144
  ds_read_b128 v[60:63], v30 offset:7168
  v_lshrrev_b32 v30, 5, v0
  v_lshlrev_b32 v30, 14, v30
  v_and_b32 v31, 31, v0
  v_lshl_add_u32 v30, v31, 4, v30
  s_lshl_b32 s24, s5, 9
  s_add_u32 s24, s24, 1052672
  s_waitcnt lgkmcnt(0)
  v_add_f32 v32, v32, v48
  v_add_f32 v33, v33, v49
  v_add_f32 v34, v34, v50
  v_add_f32 v35, v35, v51
  v_add_f32 v36, v36, v52
  v_add_f32 v37, v37, v53
  v_add_f32 v38, v38, v54
  v_add_f32 v39, v39, v55
  v_add_f32 v40, v40, v56
  v_add_f32 v41, v41, v57
  v_add_f32 v42, v42, v58
  v_add_f32 v43, v43, v59
  v_add_f32 v44, v44, v60
  v_add_f32 v45, v45, v61
  v_add_f32 v46, v46, v62
  v_add_f32 v47, v47, v63
  v_add_f32 v32, v32, v40
  v_add_f32 v33, v33, v41
  v_add_f32 v34, v34, v42
  v_add_f32 v35, v35, v43
  v_add_f32 v36, v36, v44
  v_add_f32 v37, v37, v45
  v_add_f32 v38, v38, v46
  v_add_f32 v39, v39, v47
  v_add_f32 v32, v32, v36
  v_add_f32 v33, v33, v37
  v_add_f32 v34, v34, v38
  v_add_f32 v35, v35, v39
  v_cvt_pk_bf16_f32 v32, v32, v33
  v_cvt_pk_bf16_f32 v34, v34, v35
  v_mov_b32 v33, s7
  v_mov_b32 v35, s7
  buffer_store_dwordx4 v[32:35], v30, s[16:19], s24 offen sc1
L_cq:
  s_barrier
  s_lshr_b32 s87, s63, 1
  s_lshl_b32 s62, s87, 5
  s_add_u32 s62, s62, s5
  s_mov_b32 s6, 3
  s_mov_b32 s85, 2
  s_cmp_lt_u32 s3, 4
  s_cbranch_scc1 L_b2in
  s_and_b32 s63, s63, 1
  s_branch L_stream
L_b2in:
  s_setprio 3
  s_mov_b32 s8, s44
  s_mov_b32 s9, s45
  s_mov_b32 s10, 0x1000000
  s_mov_b32 s11, 0x20000
  s_lshr_b32 s4, s2, 5
  s_mov_b32 s67, s2
  s_lshl_b32 s76, s2, 18
  s_lshl_b32 s24, s63, 14
  s_add_u32 s76, s76, s24
  s_mov_b32 s77, 67584
  s_mul_i32 s78, s63, 16896
  s_mov_b32 m0, s78
  s_mov_b32 s24, s76
  buffer_load_dwordx4 v2, s[8:11], s24 offen offset:0 nt lds
  s_add_u32 m0, m0, 32
  s_nop 0
  buffer_load_dwordx4 v2, s[8:11], s24 offen offset:1024 nt lds
  s_add_u32 m0, m0, 32
  s_nop 0
  buffer_load_dwordx4 v2, s[8:11], s24 offen offset:2048 nt lds
  s_add_u32 m0, m0, 32
  s_nop 0
  buffer_load_dwordx4 v2, s[8:11], s24 offen offset:3072 nt lds
  s_add_u32 m0, m0, 4128
  s_add_u32 s24, s24, 4096
  buffer_load_dwordx4 v2, s[8:11], s24 offen offset:0 nt lds
  s_add_u32 m0, m0, 32
  s_nop 0
  buffer_load_dwordx4 v2, s[8:11], s24 offen offset:1024 nt lds
  s_add_u32 m0, m0, 32
  s_nop 0
  buffer_load_dwordx4 v2, s[8:11], s24 offen offset:2048 nt lds
  s_add_u32 m0, m0, 32
  s_nop 0
  buffer_load_dwordx4 v2, s[8:11], s24 offen offset:3072 nt lds
  s_add_u32 m0, m0, 4128
  s_add_u32 s24, s24, 4096
  buffer_load_dwordx4 v2, s[8:11], s24 offen offset:0 nt lds
  s_add_u32 m0, m0, 32
  s_nop 0
  buffer_load_dwordx4 v2, s[8:11], s24 offen offset:1024 nt lds
  s_add_u32 m0, m0, 32
  s_nop 0
  buffer_load_dwordx4 v2, s[8:11], s24 offen offset:2048 nt lds
  s_add_u32 m0, m0, 32
  s_nop 0
  buffer_load_dwordx4 v2, s[8:11], s24 offen offset:3072 nt lds
  s_add_u32 m0, m0, 4128
  s_add_u32 s24, s24, 4096
  buffer_load_dwordx4 v2, s[8:11], s24 offen offset:0 nt lds
  s_add_u32 m0, m0, 32
  s_nop 0
  buffer_load_dwordx4 v2, s[8:11], s24 offen offset:1024 nt lds
  s_add_u32 m0, m0, 32
  s_nop 0
  buffer_load_dwordx4 v2, s[8:11], s24 offen offset:2048 nt lds
  s_add_u32 m0, m0, 32
  s_nop 0
  buffer_load_dwordx4 v2, s[8:11], s24 offen offset:3072 nt lds
  s_add_u32 s76, s76, 65536
  s_and_b32 s68, s63, 1
  s_lshr_b32 s69, s63, 1
  s_lshl_b32 s70, s68, 4
  s_lshl_b32 s71, s68, 8
  s_add_u32 s71, s71, 1089536
  v_lshlrev_b32 v30, 4, v4
  v_mov_b32 v64, 0
  v_mov_b32 v65, 0
  v_mov_b32 v66, 0
  v_mov_b32 v67, 0
  v_mov_b32 v68, 0
  v_mov_b32 v69, 0
  v_mov_b32 v70, 0
  v_mov_b32 v71, 0
  v_mov_b32 v72, 0
  v_mov_b32 v73, 0
  v_mov_b32 v74, 0
  v_mov_b32 v75, 0
  v_mov_b32 v76, 0
  v_mov_b32 v77, 0
  v_mov_b32 v78, 0
  v_mov_b32 v79, 0
  v_mov_b32 v80, 0
  v_mov_b32 v81, 0
  v_mov_b32 v82, 0
  v_mov_b32 v83, 0
  v_mov_b32 v84, 0
  v_mov_b32 v85, 0
  v_mov_b32 v86, 0
  v_mov_b32 v87, 0
  v_mov_b32 v88, 0
  v_mov_b32 v89, 0
  v_mov_b32 v90, 0
  v_mov_b32 v91, 0
  v_mov_b32 v92, 0
  v_mov_b32 v93, 0
  v_mov_b32 v94, 0
  v_mov_b32 v95, 0
  v_mov_b32 v96, 0
  v_mov_b32 v97, 0
  v_mov_b32 v98, 0
  v_mov_b32 v99, 0
  v_mov_b32 v100, 0
  v_mov_b32 v101, 0
  v_mov_b32 v102, 0
  v_mov_b32 v103, 0
  v_mov_b32 v104, 0
  v_mov_b32 v105, 0
  v_mov_b32 v106, 0
  v_mov_b32 v107, 0
  v_mov_b32 v108, 0
  v_mov_b32 v109, 0
  v_mov_b32 v110, 0
  v_mov_b32 v111, 0
  v_mov_b32 v112, 0
  v_mov_b32 v113, 0
  v_mov_b32 v114, 0
  v_mov_b32 v115, 0
  v_mov_b32 v116, 0
  v_mov_b32 v117, 0
  v_mov_b32 v118, 0
  v_mov_b32 v119, 0
  v_mov_b32 v120, 0
  v_mov_b32 v121, 0
  v_mov_b32 v122, 0
  v_mov_b32 v123, 0
  v_mov_b32 v124, 0
  v_mov_b32 v125, 0
  v_mov_b32 v126, 0
  v_mov_b32 v127, 0
  v_mov_b32 v34, 0xf149f2ca
  v_mov_b32 v38, 0
  s_mov_b32 s30, 50000
L_gp3:
  buffer_load_dwordx4 v[40:43], v30, s[16:19], s71 offen sc1
  s_waitcnt vmcnt(0)
  v_mov_b32 v28, v40
  v_mov_b32 v29, v40
  v_min3_u32 v28, v28, v41, v42
  v_max3_u32 v29, v29, v41, v42
  v_min3_u32 v28, v28, v43, v43
  v_max3_u32 v29, v29, v43, v43
  v_cmp_eq_u32 s[24:25], s7, v28
  v_cmp_eq_u32 vcc, s7, v29
  s_and_b64 vcc, vcc, s[24:25]
  s_cmp_eq_u64 vcc, -1
  s_cbranch_scc1 L_gpd4
  s_sleep 8
  s_sub_u32 s30, s30, 1
  s_cmp_lg_u32 s30, 0
  s_cbranch_scc1 L_gp3
L_gpd4:
  v_lshlrev_b32 v30, 10, v4
  v_lshl_add_u32 v30, v3, 4, v30
  s_lshl_b32 s24, s4, 5
  s_add_u32 s24, s24, s70
  s_lshl_b32 s24, s24, 10
  s_add_u32 s24, s24, 1114112
  buffer_load_dwordx4 v[128:131], v30, s[16:19], s24 offen offset:0 sc1
  buffer_load_dwordx4 v[132:135], v30, s[16:19], s24 offen offset:64 sc1
  buffer_load_dwordx4 v[136:139], v30, s[16:19], s24 offen offset:128 sc1
  buffer_load_dwordx4 v[140:143], v30, s[16:19], s24 offen offset:192 sc1
  buffer_load_dwordx4 v[144:147], v30, s[16:19], s24 offen offset:256 sc1
  buffer_load_dwordx4 v[148:151], v30, s[16:19], s24 offen offset:320 sc1
  buffer_load_dwordx4 v[152:155], v30, s[16:19], s24 offen offset:384 sc1
  buffer_load_dwordx4 v[156:159], v30, s[16:19], s24 offen offset:448 sc1
  buffer_load_dwordx4 v[160:163], v30, s[16:19], s24 offen offset:512 sc1
  buffer_load_dwordx4 v[164:167], v30, s[16:19], s24 offen offset:576 sc1
  buffer_load_dwordx4 v[168:171], v30, s[16:19], s24 offen offset:640 sc1
  buffer_load_dwordx4 v[172:175], v30, s[16:19], s24 offen offset:704 sc1
  buffer_load_dwordx4 v[176:179], v30, s[16:19], s24 offen offset:768 sc1
  buffer_load_dwordx4 v[180:183], v30, s[16:19], s24 offen offset:832 sc1
  buffer_load_dwordx4 v[184:187], v30, s[16:19], s24 offen offset:896 sc1
  buffer_load_dwordx4 v[188:191], v30, s[16:19], s24 offen offset:960 sc1
  s_add_u32 s78, s78, 67584
  s_mov_b32 m0, s78
  s_mov_b32 s24, s76
  buffer_load_dwordx4 v2, s[8:11], s24 offen offset:0 nt lds
  s_add_u32 m0, m0, 32
  s_nop 0
  buffer_load_dwordx4 v2, s[8:11], s24 offen offset:1024 nt lds
  s_add_u32 m0, m0, 32
  s_nop 0
  buffer_load_dwordx4 v2, s[8:11], s24 offen offset:2048 nt lds
  s_add_u32 m0, m0, 32
  s_nop 0
  buffer_load_dwordx4 v2, s[8:11], s24 offen offset:3072 nt lds
  s_add_u32 m0, m0, 4128
  s_add_u32 s24, s24, 4096
  buffer_load_dwordx4 v2, s[8:11], s24 offen offset:0 nt lds
  s_add_u32 m0, m0, 32
  s_nop 0
  buffer_load_dwordx4 v2, s[8:11], s24 offen offset:1024 nt lds
  s_add_u32 m0, m0, 32
  s_nop 0
  buffer_load_dwordx4 v2, s[8:11], s24 offen offset:2048 nt lds
  s_add_u32 m0, m0, 32
  s_nop 0
  buffer_load_dwordx4 v2, s[8:11], s24 offen offset:3072 nt lds
  s_add_u32 m0, m0, 4128
  s_add_u32 s24, s24, 4096
  buffer_load_dwordx4 v2, s[8:11], s24 offen offset:0 nt lds
  s_add_u32 m0, m0, 32
  s_nop 0
  buffer_load_dwordx4 v2, s[8:11], s24 offen offset:1024 nt lds
  s_add_u32 m0, m0, 32
  s_nop 0
  buffer_load_dwordx4 v2, s[8:11], s24 offen offset:2048 nt lds
  s_add_u32 m0, m0, 32
  s_nop 0
  buffer_load_dwordx4 v2, s[8:11], s24 offen offset:3072 nt lds
  s_add_u32 m0, m0, 4128
  s_add_u32 s24, s24, 4096
  buffer_load_dwordx4 v2, s[8:11], s24 offen offset:0 nt lds
  s_add_u32 m0, m0, 32
  s_nop 0
  buffer_load_dwordx4 v2, s[8:11], s24 offen offset:1024 nt lds
  s_add_u32 m0, m0, 32
  s_nop 0
  buffer_load_dwordx4 v2, s[8:11], s24 offen offset:2048 nt lds
  s_add_u32 m0, m0, 32
  s_nop 0
  buffer_load_dwordx4 v2, s[8:11], s24 offen offset:3072 nt lds
  s_add_u32 s76, s76, 65536
  s_sub_u32 s78, s78, 67584
  v_mul_u32_u24 v32, 1056, v4
  v_lshl_add_u32 v32, v3, 4, v32
  v_lshrrev_b32 v39, 2, v4
  v_lshl_add_u32 v39, v3, 2, v39
  v_mul_u32_u24 v39, 1056, v39
  v_and_b32 v33, 3, v4
  v_lshl_add_u32 v39, v33, 4, v39
  s_lshl_b32 s24, s69, 9
  v_add_u32 v39, s24, v39
  s_mov_b32 s74, 4
  s_mov_b32 s75, 0
  s_waitcnt vmcnt(16)
L_b2:
  s_waitcnt vmcnt(16)
  s_cmp_lg_u32 s74, 1
  s_cbranch_scc1 L_b2w
  s_waitcnt vmcnt(0)
L_b2w:
  s_add_u32 s75, s75, 4
  v_mov_b32 v29, 153088
  v_mov_b32 v28, 1
  s_waitcnt lgkmcnt(0)
  s_mov_b64 exec, 1
  ds_add_u32 v29, v28
  s_mov_b64 exec, -1
  s_mov_b32 s30, 50000
L_lp5:
  ds_read_b32 v28, v29
  s_waitcnt lgkmcnt(0)
  v_readfirstlane_b32 s31, v28
  s_cmp_ge_u32 s31, s75
  s_cbranch_scc1 L_lpd6
  s_sleep 1
  s_sub_u32 s30, s30, 1
  s_cmp_lg_u32 s30, 0
  s_cbranch_scc1 L_lp5
L_lpd6:
  ds_read_b128 v[192:195], v32 offset:0
  ds_read_b128 v[196:199], v32 offset:64
  ds_read_b128 v[200:203], v32 offset:128
  ds_read_b128 v[204:207], v32 offset:192
  ds_read_b128 v[208:211], v32 offset:256
  ds_read_b128 v[212:215], v32 offset:320
  ds_read_b128 v[216:219], v32 offset:384
  ds_read_b128 v[220:223], v32 offset:448
  ds_read_b128 v[224:227], v32 offset:512
  ds_read_b128 v[228:231], v32 offset:576
  ds_read_b128 v[232:235], v32 offset:640
  ds_read_b128 v[236:239], v32 offset:704
  s_waitcnt lgkmcnt(8)
  v_mfma_f32_16x16x32_bf16 v[48:51], v[192:195], v[128:131], 0
  v_mfma_f32_16x16x32_bf16 v[48:51], v[196:199], v[132:135], v[48:51]
  v_mfma_f32_16x16x32_bf16 v[48:51], v[200:203], v[136:139], v[48:51]
  v_mfma_f32_16x16x32_bf16 v[48:51], v[204:207], v[140:143], v[48:51]
  ds_read_b128 v[192:195], v32 offset:768
  ds_read_b128 v[196:199], v32 offset:832
  ds_read_b128 v[200:203], v32 offset:896
  ds_read_b128 v[204:207], v32 offset:960
  s_waitcnt lgkmcnt(8)
  v_mfma_f32_16x16x32_bf16 v[48:51], v[208:211], v[144:147], v[48:51]
  v_mfma_f32_16x16x32_bf16 v[48:51], v[212:215], v[148:151], v[48:51]
  v_mfma_f32_16x16x32_bf16 v[48:51], v[216:219], v[152:155], v[48:51]
  v_mfma_f32_16x16x32_bf16 v[48:51], v[220:223], v[156:159], v[48:51]
  ds_read_b128 v[208:211], v32 offset:16896
  ds_read_b128 v[212:215], v32 offset:16960
  ds_read_b128 v[216:219], v32 offset:17024
  ds_read_b128 v[220:223], v32 offset:17088
  s_waitcnt lgkmcnt(8)
  v_mfma_f32_16x16x32_bf16 v[48:51], v[224:227], v[160:163], v[48:51]
  v_mfma_f32_16x16x32_bf16 v[48:51], v[228:231], v[164:167], v[48:51]
  v_mfma_f32_16x16x32_bf16 v[48:51], v[232:235], v[168:171], v[48:51]
  v_mfma_f32_16x16x32_bf16 v[48:51], v[236:239], v[172:175], v[48:51]
  ds_read_b128 v[224:227], v32 offset:17152
  ds_read_b128 v[228:231], v32 offset:17216
  ds_read_b128 v[232:235], v32 offset:17280
  ds_read_b128 v[236:239], v32 offset:17344
  s_waitcnt lgkmcnt(8)
  v_mfma_f32_16x16x32_bf16 v[48:51], v[192:195], v[176:179], v[48:51]
  v_mfma_f32_16x16x32_bf16 v[48:51], v[196:199], v[180:183], v[48:51]
  v_mfma_f32_16x16x32_bf16 v[48:51], v[200:203], v[184:187], v[48:51]
  v_mfma_f32_16x16x32_bf16 v[48:51], v[204:207], v[188:191], v[48:51]
  ds_read_b128 v[192:195], v32 offset:17408
  ds_read_b128 v[196:199], v32 offset:17472
  ds_read_b128 v[200:203], v32 offset:17536
  ds_read_b128 v[204:207], v32 offset:17600
  s_waitcnt lgkmcnt(8)
  v_mfma_f32_16x16x32_bf16 v[52:55], v[208:211], v[128:131], 0
  v_mfma_f32_16x16x32_bf16 v[52:55], v[212:215], v[132:135], v[52:55]
  v_mfma_f32_16x16x32_bf16 v[52:55], v[216:219], v[136:139], v[52:55]
  v_mfma_f32_16x16x32_bf16 v[52:55], v[220:223], v[140:143], v[52:55]
  ds_read_b128 v[208:211], v32 offset:17664
  ds_read_b128 v[212:215], v32 offset:17728
  ds_read_b128 v[216:219], v32 offset:17792
  ds_read_b128 v[220:223], v32 offset:17856
  s_waitcnt lgkmcnt(8)
  v_mfma_f32_16x16x32_bf16 v[52:55], v[224:227], v[144:147], v[52:55]
  v_mfma_f32_16x16x32_bf16 v[52:55], v[228:231], v[148:151], v[52:55]
  v_mfma_f32_16x16x32_bf16 v[52:55], v[232:235], v[152:155], v[52:55]
  v_mfma_f32_16x16x32_bf16 v[52:55], v[236:239], v[156:159], v[52:55]
  ds_read_b128 v[224:227], v32 offset:33792
  ds_read_b128 v[228:231], v32 offset:33856
  ds_read_b128 v[232:235], v32 offset:33920
  ds_read_b128 v[236:239], v32 offset:33984
  s_waitcnt lgkmcnt(8)
  v_mfma_f32_16x16x32_bf16 v[52:55], v[192:195], v[160:163], v[52:55]
  v_mfma_f32_16x16x32_bf16 v[52:55], v[196:199], v[164:167], v[52:55]
  v_mfma_f32_16x16x32_bf16 v[52:55], v[200:203], v[168:171], v[52:55]
  v_mfma_f32_16x16x32_bf16 v[52:55], v[204:207], v[172:175], v[52:55]
  ds_read_b128 v[192:195], v32 offset:34048
  ds_read_b128 v[196:199], v32 offset:34112
  ds_read_b128 v[200:203], v32 offset:34176
  ds_read_b128 v[204:207], v32 offset:34240
  s_waitcnt lgkmcnt(8)
  v_mfma_f32_16x16x32_bf16 v[52:55], v[208:211], v[176:179], v[52:55]
  v_mfma_f32_16x16x32_bf16 v[52:55], v[212:215], v[180:183], v[52:55]
  v_mfma_f32_16x16x32_bf16 v[52:55], v[216:219], v[184:187], v[52:55]
  v_mfma_f32_16x16x32_bf16 v[52:55], v[220:223], v[188:191], v[52:55]
  ds_read_b128 v[208:211], v32 offset:34304
  ds_read_b128 v[212:215], v32 offset:34368
  ds_read_b128 v[216:219], v32 offset:34432
  ds_read_b128 v[220:223], v32 offset:34496
  s_waitcnt lgkmcnt(8)
  v_mfma_f32_16x16x32_bf16 v[56:59], v[224:227], v[128:131], 0
  v_mfma_f32_16x16x32_bf16 v[56:59], v[228:231], v[132:135], v[56:59]
  v_mfma_f32_16x16x32_bf16 v[56:59], v[232:235], v[136:139], v[56:59]
  v_mfma_f32_16x16x32_bf16 v[56:59], v[236:239], v[140:143], v[56:59]
  ds_read_b128 v[224:227], v32 offset:34560
  ds_read_b128 v[228:231], v32 offset:34624
  ds_read_b128 v[232:235], v32 offset:34688
  ds_read_b128 v[236:239], v32 offset:34752
  s_waitcnt lgkmcnt(8)
  v_mfma_f32_16x16x32_bf16 v[56:59], v[192:195], v[144:147], v[56:59]
  v_mfma_f32_16x16x32_bf16 v[56:59], v[196:199], v[148:151], v[56:59]
  v_mfma_f32_16x16x32_bf16 v[56:59], v[200:203], v[152:155], v[56:59]
  v_mfma_f32_16x16x32_bf16 v[56:59], v[204:207], v[156:159], v[56:59]
  ds_read_b128 v[192:195], v32 offset:50688
  ds_read_b128 v[196:199], v32 offset:50752
  ds_read_b128 v[200:203], v32 offset:50816
  ds_read_b128 v[204:207], v32 offset:50880
  s_waitcnt lgkmcnt(8)
  v_mfma_f32_16x16x32_bf16 v[56:59], v[208:211], v[160:163], v[56:59]
  v_mfma_f32_16x16x32_bf16 v[56:59], v[212:215], v[164:167], v[56:59]
  v_mfma_f32_16x16x32_bf16 v[56:59], v[216:219], v[168:171], v[56:59]
  v_mfma_f32_16x16x32_bf16 v[56:59], v[220:223], v[172:175], v[56:59]
  ds_read_b128 v[208:211], v32 offset:50944
  ds_read_b128 v[212:215], v32 offset:51008
  ds_read_b128 v[216:219], v32 offset:51072
  ds_read_b128 v[220:223], v32 offset:51136
  s_waitcnt lgkmcnt(8)
  v_mfma_f32_16x16x32_bf16 v[56:59], v[224:227], v[176:179], v[56:59]
  v_mfma_f32_16x16x32_bf16 v[56:59], v[228:231], v[180:183], v[56:59]
  v_mfma_f32_16x16x32_bf16 v[56:59], v[232:235], v[184:187], v[56:59]
  v_mfma_f32_16x16x32_bf16 v[56:59], v[236:239], v[188:191], v[56:59]
  ds_read_b128 v[224:227], v32 offset:51200
  ds_read_b128 v[228:231], v32 offset:51264
  ds_read_b128 v[232:235], v32 offset:51328
  ds_read_b128 v[236:239], v32 offset:51392
  s_waitcnt lgkmcnt(8)
  v_mfma_f32_16x16x32_bf16 v[60:63], v[192:195], v[128:131], 0
  v_mfma_f32_16x16x32_bf16 v[60:63], v[196:199], v[132:135], v[60:63]
  v_mfma_f32_16x16x32_bf16 v[60:63], v[200:203], v[136:139], v[60:63]
  v_mfma_f32_16x16x32_bf16 v[60:63], v[204:207], v[140:143], v[60:63]
  ds_read_b128 v[192:195], v32 offset:51456
  ds_read_b128 v[196:199], v32 offset:51520
  ds_read_b128 v[200:203], v32 offset:51584
  ds_read_b128 v[204:207], v32 offset:51648
  s_waitcnt lgkmcnt(8)
  v_mfma_f32_16x16x32_bf16 v[60:63], v[208:211], v[144:147], v[60:63]
  v_mfma_f32_16x16x32_bf16 v[60:63], v[212:215], v[148:151], v[60:63]
  v_mfma_f32_16x16x32_bf16 v[60:63], v[216:219], v[152:155], v[60:63]
  v_mfma_f32_16x16x32_bf16 v[60:63], v[220:223], v[156:159], v[60:63]
  s_waitcnt lgkmcnt(4)
  v_mfma_f32_16x16x32_bf16 v[60:63], v[224:227], v[160:163], v[60:63]
  v_mfma_f32_16x16x32_bf16 v[60:63], v[228:231], v[164:167], v[60:63]
  v_mfma_f32_16x16x32_bf16 v[60:63], v[232:235], v[168:171], v[60:63]
  v_mfma_f32_16x16x32_bf16 v[60:63], v[236:239], v[172:175], v[60:63]
  s_waitcnt lgkmcnt(0)
  v_mfma_f32_16x16x32_bf16 v[60:63], v[192:195], v[176:179], v[60:63]
  v_mfma_f32_16x16x32_bf16 v[60:63], v[196:199], v[180:183], v[60:63]
  v_mfma_f32_16x16x32_bf16 v[60:63], v[200:203], v[184:187], v[60:63]
  v_mfma_f32_16x16x32_bf16 v[60:63], v[204:207], v[188:191], v[60:63]
  ds_read_b64_tr_b16 v[192:193], v39 offset:0
  ds_read_b64_tr_b16 v[194:195], v39 offset:16896
  ds_read_b64_tr_b16 v[196:197], v39 offset:33792
  ds_read_b64_tr_b16 v[198:199], v39 offset:50688
  ds_read_b64_tr_b16 v[200:201], v39 offset:8
  ds_read_b64_tr_b16 v[202:203], v39 offset:16904
  ds_read_b64_tr_b16 v[204:205], v39 offset:33800
  ds_read_b64_tr_b16 v[206:207], v39 offset:50696
  v_cvt_pk_bf16_f32 v40, v48, v49
  v_cvt_pk_bf16_f32 v41, v50, v51
  v_cvt_pk_bf16_f32 v42, v52, v53
  v_cvt_pk_bf16_f32 v43, v54, v55
  v_cvt_pk_bf16_f32 v44, v56, v57
  v_cvt_pk_bf16_f32 v45, v58, v59
  v_cvt_pk_bf16_f32 v46, v60, v61
  v_cvt_pk_bf16_f32 v47, v62, v63
  v_lshlrev_b32 v48, 16, v40
  v_and_b32 v49, 0xffff0000, v40
  v_lshlrev_b32 v50, 16, v41
  v_and_b32 v51, 0xffff0000, v41
  v_lshlrev_b32 v52, 16, v42
  v_and_b32 v53, 0xffff0000, v42
  v_lshlrev_b32 v54, 16, v43
  v_and_b32 v55, 0xffff0000, v43
  v_lshlrev_b32 v56, 16, v44
  v_and_b32 v57, 0xffff0000, v44
  v_lshlrev_b32 v58, 16, v45
  v_and_b32 v59, 0xffff0000, v45
  v_lshlrev_b32 v60, 16, v46
  v_and_b32 v61, 0xffff0000, v46
  v_lshlrev_b32 v62, 16, v47
  v_and_b32 v63, 0xffff0000, v47
  v_mul_f32 v48, s26, v48
  v_mul_f32 v49, s26, v49
  v_mul_f32 v50, s26, v50
  v_mul_f32 v51, s26, v51
  v_mul_f32 v52, s26, v52
  v_mul_f32 v53, s26, v53
  v_mul_f32 v54, s26, v54
  v_mul_f32 v55, s26, v55
  v_mul_f32 v56, s26, v56
  v_mul_f32 v57, s26, v57
  v_mul_f32 v58, s26, v58
  v_mul_f32 v59, s26, v59
  v_mul_f32 v60, s26, v60
  v_mul_f32 v61, s26, v61
  v_mul_f32 v62, s26, v62
  v_mul_f32 v63, s26, v63
  v_cvt_pk_bf16_f32 v40, v48, v49
  v_cvt_pk_bf16_f32 v41, v50, v51
  v_cvt_pk_bf16_f32 v42, v52, v53
  v_cvt_pk_bf16_f32 v43, v54, v55
  v_cvt_pk_bf16_f32 v44, v56, v57
  v_cvt_pk_bf16_f32 v45, v58, v59
  v_cvt_pk_bf16_f32 v46, v60, v61
  v_cvt_pk_bf16_f32 v47, v62, v63
  v_lshlrev_b32 v48, 16, v40
  v_and_b32 v49, 0xffff0000, v40
  v_lshlrev_b32 v50, 16, v41
  v_and_b32 v51, 0xffff0000, v41
  v_lshlrev_b32 v52, 16, v42
  v_and_b32 v53, 0xffff0000, v42
  v_lshlrev_b32 v54, 16, v43
  v_and_b32 v55, 0xffff0000, v43
  v_lshlrev_b32 v56, 16, v44
  v_and_b32 v57, 0xffff0000, v44
  v_lshlrev_b32 v58, 16, v45
  v_and_b32 v59, 0xffff0000, v45
  v_lshlrev_b32 v60, 16, v46
  v_and_b32 v61, 0xffff0000, v46
  v_lshlrev_b32 v62, 16, v47
  v_and_b32 v63, 0xffff0000, v47
  v_max3_f32 v35, v48, v49, v34
  v_max3_f32 v35, v35, v50, v51
  v_max3_f32 v35, v35, v52, v53
  v_max3_f32 v35, v35, v54, v55
  v_max3_f32 v35, v35, v56, v57
  v_max3_f32 v35, v35, v58, v59
  v_max3_f32 v35, v35, v60, v61
  v_max3_f32 v35, v35, v62, v63
  v_mov_b32 v36, v35
  s_nop 1
  v_permlane16_swap_b32 v35, v36
  v_max_f32 v35, v35, v36
  v_mov_b32 v36, v35
  s_nop 1
  v_permlane32_swap_b32 v35, v36
  v_max_f32 v35, v35, v36
  v_sub_f32 v37, v34, v35
  v_mul_f32 v37, 0x3fb8aa3b, v37
  v_exp_f32 v37, v37
  v_mov_b32 v34, v35
  v_mul_f32 v35, 0x3fb8aa3b, v35
  v_mov_b32 v36, 0x3fb8aa3b
  v_fma_f32 v48, v48, v36, -v35
  v_fma_f32 v49, v49, v36, -v35
  v_fma_f32 v50, v50, v36, -v35
  v_fma_f32 v51, v51, v36, -v35
  v_fma_f32 v52, v52, v36, -v35
  v_fma_f32 v53, v53, v36, -v35
  v_fma_f32 v54, v54, v36, -v35
  v_fma_f32 v55, v55, v36, -v35
  v_fma_f32 v56, v56, v36, -v35
  v_fma_f32 v57, v57, v36, -v35
  v_fma_f32 v58, v58, v36, -v35
  v_fma_f32 v59, v59, v36, -v35
  v_fma_f32 v60, v60, v36, -v35
  v_fma_f32 v61, v61, v36, -v35
  v_fma_f32 v62, v62, v36, -v35
  v_fma_f32 v63, v63, v36, -v35
  v_exp_f32 v48, v48
  v_exp_f32 v49, v49
  v_exp_f32 v50, v50
  v_exp_f32 v51, v51
  v_exp_f32 v52, v52
  v_exp_f32 v53, v53
  v_exp_f32 v54, v54
  v_exp_f32 v55, v55
  v_exp_f32 v56, v56
  v_exp_f32 v57, v57
  v_exp_f32 v58, v58
  v_exp_f32 v59, v59
  v_exp_f32 v60, v60
  v_exp_f32 v61, v61
  v_exp_f32 v62, v62
  v_exp_f32 v63, v63
  v_mul_f32 v64, v37, v64
  v_mul_f32 v65, v37, v65
  v_mul_f32 v66, v37, v66
  v_mul_f32 v67, v37, v67
  v_mul_f32 v68, v37, v68
  v_mul_f32 v69, v37, v69
  v_mul_f32 v70, v37, v70
  v_mul_f32 v71, v37, v71
  v_mul_f32 v72, v37, v72
  v_mul_f32 v73, v37, v73
  v_mul_f32 v74, v37, v74
  v_mul_f32 v75, v37, v75
  v_mul_f32 v76, v37, v76
  v_mul_f32 v77, v37, v77
  v_mul_f32 v78, v37, v78
  v_mul_f32 v79, v37, v79
  v_mul_f32 v80, v37, v80
  v_mul_f32 v81, v37, v81
  v_mul_f32 v82, v37, v82
  v_mul_f32 v83, v37, v83
  v_mul_f32 v84, v37, v84
  v_mul_f32 v85, v37, v85
  v_mul_f32 v86, v37, v86
  v_mul_f32 v87, v37, v87
  v_mul_f32 v88, v37, v88
  v_mul_f32 v89, v37, v89
  v_mul_f32 v90, v37, v90
  v_mul_f32 v91, v37, v91
  v_mul_f32 v92, v37, v92
  v_mul_f32 v93, v37, v93
  v_mul_f32 v94, v37, v94
  v_mul_f32 v95, v37, v95
  v_mul_f32 v96, v37, v96
  v_mul_f32 v97, v37, v97
  v_mul_f32 v98, v37, v98
  v_mul_f32 v99, v37, v99
  v_mul_f32 v100, v37, v100
  v_mul_f32 v101, v37, v101
  v_mul_f32 v102, v37, v102
  v_mul_f32 v103, v37, v103
  v_mul_f32 v104, v37, v104
  v_mul_f32 v105, v37, v105
  v_mul_f32 v106, v37, v106
  v_mul_f32 v107, v37, v107
  v_mul_f32 v108, v37, v108
  v_mul_f32 v109, v37, v109
  v_mul_f32 v110, v37, v110
  v_mul_f32 v111, v37, v111
  v_mul_f32 v112, v37, v112
  v_mul_f32 v113, v37, v113
  v_mul_f32 v114, v37, v114
  v_mul_f32 v115, v37, v115
  v_mul_f32 v116, v37, v116
  v_mul_f32 v117, v37, v117
  v_mul_f32 v118, v37, v118
  v_mul_f32 v119, v37, v119
  v_mul_f32 v120, v37, v120
  v_mul_f32 v121, v37, v121
  v_mul_f32 v122, v37, v122
  v_mul_f32 v123, v37, v123
  v_mul_f32 v124, v37, v124
  v_mul_f32 v125, v37, v125
  v_mul_f32 v126, v37, v126
  v_mul_f32 v127, v37, v127
  v_cvt_pk_bf16_f32 v40, v48, v49
  v_cvt_pk_bf16_f32 v41, v50, v51
  v_cvt_pk_bf16_f32 v42, v52, v53
  v_cvt_pk_bf16_f32 v43, v54, v55
  v_cvt_pk_bf16_f32 v44, v56, v57
  v_cvt_pk_bf16_f32 v45, v58, v59
  v_cvt_pk_bf16_f32 v46, v60, v61
  v_cvt_pk_bf16_f32 v47, v62, v63
  v_add_f32 v48, v48, v56
  v_add_f32 v49, v49, v57
  v_add_f32 v50, v50, v58
  v_add_f32 v51, v51, v59
  v_add_f32 v52, v52, v60
  v_add_f32 v53, v53, v61
  v_add_f32 v54, v54, v62
  v_add_f32 v55, v55, v63
  v_add_f32 v48, v48, v52
  v_add_f32 v49, v49, v53
  v_add_f32 v50, v50, v54
  v_add_f32 v51, v51, v55
  v_add_f32 v48, v48, v50
  v_add_f32 v49, v49, v51
  v_add_f32 v48, v48, v49
  v_fma_f32 v38, v38, v37, v48
  ds_read_b64_tr_b16 v[208:209], v39 offset:64
  ds_read_b64_tr_b16 v[210:211], v39 offset:16960
  ds_read_b64_tr_b16 v[212:213], v39 offset:33856
  ds_read_b64_tr_b16 v[214:215], v39 offset:50752
  s_waitcnt lgkmcnt(8)
  v_mfma_f32_16x16x32_bf16 v[64:67], v[192:195], v[40:43], v[64:67]
  v_mfma_f32_16x16x32_bf16 v[64:67], v[196:199], v[44:47], v[64:67]
  ds_read_b64_tr_b16 v[192:193], v39 offset:72
  ds_read_b64_tr_b16 v[194:195], v39 offset:16968
  ds_read_b64_tr_b16 v[196:197], v39 offset:33864
  ds_read_b64_tr_b16 v[198:199], v39 offset:50760
  s_waitcnt lgkmcnt(8)
  v_mfma_f32_16x16x32_bf16 v[68:71], v[200:203], v[40:43], v[68:71]
  v_mfma_f32_16x16x32_bf16 v[68:71], v[204:207], v[44:47], v[68:71]
  ds_read_b64_tr_b16 v[200:201], v39 offset:128
  ds_read_b64_tr_b16 v[202:203], v39 offset:17024
  ds_read_b64_tr_b16 v[204:205], v39 offset:33920
  ds_read_b64_tr_b16 v[206:207], v39 offset:50816
  s_waitcnt lgkmcnt(8)
  v_mfma_f32_16x16x32_bf16 v[72:75], v[208:211], v[40:43], v[72:75]
  v_mfma_f32_16x16x32_bf16 v[72:75], v[212:215], v[44:47], v[72:75]
  ds_read_b64_tr_b16 v[208:209], v39 offset:136
  ds_read_b64_tr_b16 v[210:211], v39 offset:17032
  ds_read_b64_tr_b16 v[212:213], v39 offset:33928
  ds_read_b64_tr_b16 v[214:215], v39 offset:50824
  s_waitcnt lgkmcnt(8)
  v_mfma_f32_16x16x32_bf16 v[76:79], v[192:195], v[40:43], v[76:79]
  v_mfma_f32_16x16x32_bf16 v[76:79], v[196:199], v[44:47], v[76:79]
  ds_read_b64_tr_b16 v[192:193], v39 offset:192
  ds_read_b64_tr_b16 v[194:195], v39 offset:17088
  ds_read_b64_tr_b16 v[196:197], v39 offset:33984
  ds_read_b64_tr_b16 v[198:199], v39 offset:50880
  s_waitcnt lgkmcnt(8)
  v_mfma_f32_16x16x32_bf16 v[80:83], v[200:203], v[40:43], v[80:83]
  v_mfma_f32_16x16x32_bf16 v[80:83], v[204:207], v[44:47], v[80:83]
  ds_read_b64_tr_b16 v[200:201], v39 offset:200
  ds_read_b64_tr_b16 v[202:203], v39 offset:17096
  ds_read_b64_tr_b16 v[204:205], v39 offset:33992
  ds_read_b64_tr_b16 v[206:207], v39 offset:50888
  s_waitcnt lgkmcnt(8)
  v_mfma_f32_16x16x32_bf16 v[84:87], v[208:211], v[40:43], v[84:87]
  v_mfma_f32_16x16x32_bf16 v[84:87], v[212:215], v[44:47], v[84:87]
  ds_read_b64_tr_b16 v[208:209], v39 offset:256
  ds_read_b64_tr_b16 v[210:211], v39 offset:17152
  ds_read_b64_tr_b16 v[212:213], v39 offset:34048
  ds_read_b64_tr_b16 v[214:215], v39 offset:50944
  s_waitcnt lgkmcnt(8)
  v_mfma_f32_16x16x32_bf16 v[88:91], v[192:195], v[40:43], v[88:91]
  v_mfma_f32_16x16x32_bf16 v[88:91], v[196:199], v[44:47], v[88:91]
  ds_read_b64_tr_b16 v[192:193], v39 offset:264
  ds_read_b64_tr_b16 v[194:195], v39 offset:17160
  ds_read_b64_tr_b16 v[196:197], v39 offset:34056
  ds_read_b64_tr_b16 v[198:199], v39 offset:50952
  s_waitcnt lgkmcnt(8)
  v_mfma_f32_16x16x32_bf16 v[92:95], v[200:203], v[40:43], v[92:95]
  v_mfma_f32_16x16x32_bf16 v[92:95], v[204:207], v[44:47], v[92:95]
  ds_read_b64_tr_b16 v[200:201], v39 offset:320
  ds_read_b64_tr_b16 v[202:203], v39 offset:17216
  ds_read_b64_tr_b16 v[204:205], v39 offset:34112
  ds_read_b64_tr_b16 v[206:207], v39 offset:51008
  s_waitcnt lgkmcnt(8)
  v_mfma_f32_16x16x32_bf16 v[96:99], v[208:211], v[40:43], v[96:99]
  v_mfma_f32_16x16x32_bf16 v[96:99], v[212:215], v[44:47], v[96:99]
  ds_read_b64_tr_b16 v[208:209], v39 offset:328
  ds_read_b64_tr_b16 v[210:211], v39 offset:17224
  ds_read_b64_tr_b16 v[212:213], v39 offset:34120
  ds_read_b64_tr_b16 v[214:215], v39 offset:51016
  s_waitcnt lgkmcnt(8)
  v_mfma_f32_16x16x32_bf16 v[100:103], v[192:195], v[40:43], v[100:103]
  v_mfma_f32_16x16x32_bf16 v[100:103], v[196:199], v[44:47], v[100:103]
  ds_read_b64_tr_b16 v[192:193], v39 offset:384
  ds_read_b64_tr_b16 v[194:195], v39 offset:17280
  ds_read_b64_tr_b16 v[196:197], v39 offset:34176
  ds_read_b64_tr_b16 v[198:199], v39 offset:51072
  s_waitcnt lgkmcnt(8)
  v_mfma_f32_16x16x32_bf16 v[104:107], v[200:203], v[40:43], v[104:107]
  v_mfma_f32_16x16x32_bf16 v[104:107], v[204:207], v[44:47], v[104:107]
  ds_read_b64_tr_b16 v[200:201], v39 offset:392
  ds_read_b64_tr_b16 v[202:203], v39 offset:17288
  ds_read_b64_tr_b16 v[204:205], v39 offset:34184
  ds_read_b64_tr_b16 v[206:207], v39 offset:51080
  s_waitcnt lgkmcnt(8)
  v_mfma_f32_16x16x32_bf16 v[108:111], v[208:211], v[40:43], v[108:111]
  v_mfma_f32_16x16x32_bf16 v[108:111], v[212:215], v[44:47], v[108:111]
  ds_read_b64_tr_b16 v[208:209], v39 offset:448
  ds_read_b64_tr_b16 v[210:211], v39 offset:17344
  ds_read_b64_tr_b16 v[212:213], v39 offset:34240
  ds_read_b64_tr_b16 v[214:215], v39 offset:51136
  s_waitcnt lgkmcnt(8)
  v_mfma_f32_16x16x32_bf16 v[112:115], v[192:195], v[40:43], v[112:115]
  v_mfma_f32_16x16x32_bf16 v[112:115], v[196:199], v[44:47], v[112:115]
  ds_read_b64_tr_b16 v[192:193], v39 offset:456
  ds_read_b64_tr_b16 v[194:195], v39 offset:17352
  ds_read_b64_tr_b16 v[196:197], v39 offset:34248
  ds_read_b64_tr_b16 v[198:199], v39 offset:51144
  s_waitcnt lgkmcnt(8)
  v_mfma_f32_16x16x32_bf16 v[116:119], v[200:203], v[40:43], v[116:119]
  v_mfma_f32_16x16x32_bf16 v[116:119], v[204:207], v[44:47], v[116:119]
  s_waitcnt lgkmcnt(4)
  v_mfma_f32_16x16x32_bf16 v[120:123], v[208:211], v[40:43], v[120:123]
  v_mfma_f32_16x16x32_bf16 v[120:123], v[212:215], v[44:47], v[120:123]
  s_waitcnt lgkmcnt(0)
  v_mfma_f32_16x16x32_bf16 v[124:127], v[192:195], v[40:43], v[124:127]
  v_mfma_f32_16x16x32_bf16 v[124:127], v[196:199], v[44:47], v[124:127]
  s_sub_u32 s74, s74, 1
  s_cmp_eq_u32 s74, 0
  s_cbranch_scc1 L_b2e
  v_add_u32 v32, s77, v32
  v_add_u32 v39, s77, v39
  s_cmp_eq_u32 s74, 1
  s_cbranch_scc1 L_b2
  s_add_u32 s75, s75, 4
  v_mov_b32 v29, 153088
  v_mov_b32 v28, 1
  s_waitcnt lgkmcnt(0)
  s_mov_b64 exec, 1
  ds_add_u32 v29, v28
  s_mov_b64 exec, -1
  s_mov_b32 s30, 50000
L_lp7:
  ds_read_b32 v28, v29
  s_waitcnt lgkmcnt(0)
  v_readfirstlane_b32 s31, v28
  s_cmp_ge_u32 s31, s75
  s_cbranch_scc1 L_lpd8
  s_sleep 1
  s_sub_u32 s30, s30, 1
  s_cmp_lg_u32 s30, 0
  s_cbranch_scc1 L_lp7
L_lpd8:
  s_mov_b32 m0, s78
  s_mov_b32 s24, s76
  buffer_load_dwordx4 v2, s[8:11], s24 offen offset:0 nt lds
  s_add_u32 m0, m0, 32
  s_nop 0
  buffer_load_dwordx4 v2, s[8:11], s24 offen offset:1024 nt lds
  s_add_u32 m0, m0, 32
  s_nop 0
  buffer_load_dwordx4 v2, s[8:11], s24 offen offset:2048 nt lds
  s_add_u32 m0, m0, 32
  s_nop 0
  buffer_load_dwordx4 v2, s[8:11], s24 offen offset:3072 nt lds
  s_add_u32 m0, m0, 4128
  s_add_u32 s24, s24, 4096
  buffer_load_dwordx4 v2, s[8:11], s24 offen offset:0 nt lds
  s_add_u32 m0, m0, 32
  s_nop 0
  buffer_load_dwordx4 v2, s[8:11], s24 offen offset:1024 nt lds
  s_add_u32 m0, m0, 32
  s_nop 0
  buffer_load_dwordx4 v2, s[8:11], s24 offen offset:2048 nt lds
  s_add_u32 m0, m0, 32
  s_nop 0
  buffer_load_dwordx4 v2, s[8:11], s24 offen offset:3072 nt lds
  s_add_u32 m0, m0, 4128
  s_add_u32 s24, s24, 4096
  buffer_load_dwordx4 v2, s[8:11], s24 offen offset:0 nt lds
  s_add_u32 m0, m0, 32
  s_nop 0
  buffer_load_dwordx4 v2, s[8:11], s24 offen offset:1024 nt lds
  s_add_u32 m0, m0, 32
  s_nop 0
  buffer_load_dwordx4 v2, s[8:11], s24 offen offset:2048 nt lds
  s_add_u32 m0, m0, 32
  s_nop 0
  buffer_load_dwordx4 v2, s[8:11], s24 offen offset:3072 nt lds
  s_add_u32 m0, m0, 4128
  s_add_u32 s24, s24, 4096
  buffer_load_dwordx4 v2, s[8:11], s24 offen offset:0 nt lds
  s_add_u32 m0, m0, 32
  s_nop 0
  buffer_load_dwordx4 v2, s[8:11], s24 offen offset:1024 nt lds
  s_add_u32 m0, m0, 32
  s_nop 0
  buffer_load_dwordx4 v2, s[8:11], s24 offen offset:2048 nt lds
  s_add_u32 m0, m0, 32
  s_nop 0
  buffer_load_dwordx4 v2, s[8:11], s24 offen offset:3072 nt lds
  s_add_u32 s76, s76, 65536
  s_add_u32 s78, s78, s77
  s_sub_u32 s77, 0, s77
  s_branch L_b2
L_b2e:
  v_mov_b32 v36, v38
  s_nop 1
  v_permlane16_swap_b32 v38, v36
  v_add_f32 v38, v38, v36
  v_mov_b32 v36, v38
  s_nop 1
  v_permlane32_swap_b32 v38, v36
  v_add_f32 v38, v38, v36
  v_lshlrev_b32 v36, 16, v4
  v_lshl_add_u32 v36, v3, 4, v36
  s_lshl_b32 s72, s70, 16
  s_lshl_b32 s24, s69, 15
  s_add_u32 s72, s72, s24
  s_lshl_b32 s24, s67, 8
  s_add_u32 s72, s72, s24
  s_add_u32 s72, s72, 3145728
  s_add_u32 s73, s72, 16384
  v_cvt_pk_bf16_f32 v192, v64, v65
  v_cvt_pk_bf16_f32 v193, v66, v67
  v_cvt_pk_bf16_f32 v194, v68, v69
  v_cvt_pk_bf16_f32 v195, v70, v71
  buffer_store_dwordx4 v[192:195], v36, s[16:19], s72 offen offset:0 sc1
  v_cvt_pk_bf16_f32 v196, v72, v73
  v_cvt_pk_bf16_f32 v197, v74, v75
  v_cvt_pk_bf16_f32 v198, v76, v77
  v_cvt_pk_bf16_f32 v199, v78, v79
  buffer_store_dwordx4 v[196:199], v36, s[16:19], s72 offen offset:64 sc1
  v_cvt_pk_bf16_f32 v200, v80, v81
  v_cvt_pk_bf16_f32 v201, v82, v83
  v_cvt_pk_bf16_f32 v202, v84, v85
  v_cvt_pk_bf16_f32 v203, v86, v87
  buffer_store_dwordx4 v[200:203], v36, s[16:19], s72 offen offset:128 sc1
  v_cvt_pk_bf16_f32 v204, v88, v89
  v_cvt_pk_bf16_f32 v205, v90, v91
  v_cvt_pk_bf16_f32 v206, v92, v93
  v_cvt_pk_bf16_f32 v207, v94, v95
  buffer_store_dwordx4 v[204:207], v36, s[16:19], s72 offen offset:192 sc1
  v_cvt_pk_bf16_f32 v208, v96, v97
  v_cvt_pk_bf16_f32 v209, v98, v99
  v_cvt_pk_bf16_f32 v210, v100, v101
  v_cvt_pk_bf16_f32 v211, v102, v103
  buffer_store_dwordx4 v[208:211], v36, s[16:19], s73 offen offset:0 sc1
  v_cvt_pk_bf16_f32 v212, v104, v105
  v_cvt_pk_bf16_f32 v213, v106, v107
  v_cvt_pk_bf16_f32 v214, v108, v109
  v_cvt_pk_bf16_f32 v215, v110, v111
  buffer_store_dwordx4 v[212:215], v36, s[16:19], s73 offen offset:64 sc1
  v_cvt_pk_bf16_f32 v216, v112, v113
  v_cvt_pk_bf16_f32 v217, v114, v115
  v_cvt_pk_bf16_f32 v218, v116, v117
  v_cvt_pk_bf16_f32 v219, v118, v119
  buffer_store_dwordx4 v[216:219], v36, s[16:19], s73 offen offset:128 sc1
  v_cvt_pk_bf16_f32 v220, v120, v121
  v_cvt_pk_bf16_f32 v221, v122, v123
  v_cvt_pk_bf16_f32 v222, v124, v125
  v_cvt_pk_bf16_f32 v223, v126, v127
  buffer_store_dwordx4 v[220:223], v36, s[16:19], s73 offen offset:192 sc1
  v_mov_b32 v40, v34
  v_mov_b32 v41, s7
  v_mov_b32 v42, v38
  v_mov_b32 v43, s7
  v_lshlrev_b32 v36, 11, v4
  s_lshl_b32 s24, s70, 11
  s_lshl_b32 s25, s69, 10
  s_add_u32 s24, s24, s25
  s_lshl_b32 s25, s67, 4
  s_add_u32 s24, s24, s25
  s_add_u32 s24, s24, 1179648
  s_mov_b64 exec, 0xffff
  s_waitcnt vmcnt(0)
  buffer_store_dwordx4 v[40:43], v36, s[16:19], s24 offen sc1
  s_mov_b64 exec, -1
  s_branch L_tail
L_wwg:
  s_lshl_b32 s64, s63, 20
  s_add_u32 s64, s64, s65
  s_lshl_b32 s27, s63, 8
  v_lshlrev_b32 v5, 18, v3
  v_lshl_add_u32 v5, v4, 4, v5
  v_lshl_add_u32 v28, v3, 6, v28
  v_lshlrev_b32 v6, 15, v3
  v_lshl_add_u32 v6, v4, 4, v6
  v_lshrrev_b32 v47, 3, v4
  v_lshlrev_b32 v7, 8, v47
  v_lshl_add_u32 v7, v3, 6, v7
  v_lshlrev_b32 v47, 7, v47
  v_lshl_add_u32 v47, v1, 4, v47
  v_lshl_add_u32 v47, v3, 14, v47
  s_lshl_b32 s77, s63, 16
  s_add_u32 s77, s77, s65
  s_add_u32 s77, s77, 1835008
  s_and_b32 s80, s2, 3
  s_lshl_b32 s79, s80, 16
  s_lshl_b32 s80, s80, 4
  s_cmp_ge_u32 s3, 4
  s_cbranch_scc1 L_setb
  s_mov_b32 s8, s46
  s_mov_b32 s9, s47
  s_mov_b32 s10, 0x400000
  s_mov_b32 s11, 0x20000
  s_setprio 3
  s_add_u32 s24, s80, 0
  s_and_b32 s24, s24, 63
  s_add_u32 s24, s24, s27
  buffer_load_dwordx4 v[112:115], v28, s[20:23], s24 offen
  s_add_u32 s24, s80, 16
  s_and_b32 s24, s24, 63
  s_add_u32 s24, s24, s27
  buffer_load_dwordx4 v[116:119], v28, s[20:23], s24 offen
  s_add_u32 s24, s80, 32
  s_and_b32 s24, s24, 63
  s_add_u32 s24, s24, s27
  buffer_load_dwordx4 v[120:123], v28, s[20:23], s24 offen
  s_add_u32 s24, s80, 48
  s_and_b32 s24, s24, 63
  s_add_u32 s24, s24, s27
  buffer_load_dwordx4 v[124:127], v28, s[20:23], s24 offen
  s_mov_b32 s25, s79
  s_add_u32 s24, s64, s25
  buffer_load_dwordx4 v[128:131], v5, s[8:11], s24 offen nt
  s_add_u32 s25, s25, 8192
  s_and_b32 s25, s25, 0x3ffff
  s_add_u32 s24, s64, s25
  buffer_load_dwordx4 v[132:135], v5, s[8:11], s24 offen nt
  s_add_u32 s25, s25, 8192
  s_and_b32 s25, s25, 0x3ffff
  s_add_u32 s24, s64, s25
  buffer_load_dwordx4 v[136:139], v5, s[8:11], s24 offen nt
  s_add_u32 s25, s25, 8192
  s_and_b32 s25, s25, 0x3ffff
  s_add_u32 s24, s64, s25
  buffer_load_dwordx4 v[140:143], v5, s[8:11], s24 offen nt
  s_add_u32 s25, s25, 8192
  s_and_b32 s25, s25, 0x3ffff
  s_add_u32 s24, s64, s25
  buffer_load_dwordx4 v[144:147], v5, s[8:11], s24 offen nt
  s_add_u32 s25, s25, 8192
  s_and_b32 s25, s25, 0x3ffff
  s_add_u32 s24, s64, s25
  buffer_load_dwordx4 v[148:151], v5, s[8:11], s24 offen nt
  s_add_u32 s25, s25, 8192
  s_and_b32 s25, s25, 0x3ffff
  s_add_u32 s24, s64, s25
  buffer_load_dwordx4 v[152:155], v5, s[8:11], s24 offen nt
  s_add_u32 s25, s25, 8192
  s_and_b32 s25, s25, 0x3ffff
  s_add_u32 s24, s64, s25
  buffer_load_dwordx4 v[156:159], v5, s[8:11], s24 offen nt
  s_add_u32 s25, s25, 8192
  s_and_b32 s25, s25, 0x3ffff
  s_add_u32 s24, s64, s25
  buffer_load_dwordx4 v[160:163], v5, s[8:11], s24 offen nt
  s_add_u32 s25, s25, 8192
  s_and_b32 s25, s25, 0x3ffff
  s_add_u32 s24, s64, s25
  buffer_load_dwordx4 v[164:167], v5, s[8:11], s24 offen nt
  s_add_u32 s25, s25, 8192
  s_and_b32 s25, s25, 0x3ffff
  s_add_u32 s24, s64, s25
  buffer_load_dwordx4 v[168:171], v5, s[8:11], s24 offen nt
  s_add_u32 s25, s25, 8192
  s_and_b32 s25, s25, 0x3ffff
  s_add_u32 s24, s64, s25
  buffer_load_dwordx4 v[172:175], v5, s[8:11], s24 offen nt
  s_add_u32 s25, s25, 8192
  s_and_b32 s25, s25, 0x3ffff
  s_add_u32 s24, s64, s25
  buffer_load_dwordx4 v[176:179], v5, s[8:11], s24 offen nt
  s_add_u32 s25, s25, 8192
  s_and_b32 s25, s25, 0x3ffff
  s_add_u32 s24, s64, s25
  buffer_load_dwordx4 v[180:183], v5, s[8:11], s24 offen nt
  s_add_u32 s25, s25, 8192
  s_and_b32 s25, s25, 0x3ffff
  s_add_u32 s24, s64, s25
  buffer_load_dwordx4 v[184:187], v5, s[8:11], s24 offen nt
  s_add_u32 s25, s25, 8192
  s_and_b32 s25, s25, 0x3ffff
  s_add_u32 s24, s64, s25
  buffer_load_dwordx4 v[188:191], v5, s[8:11], s24 offen nt
  s_add_u32 s25, s25, 8192
  s_and_b32 s25, s25, 0x3ffff
  s_add_u32 s24, s64, s25
  buffer_load_dwordx4 v[192:195], v5, s[8:11], s24 offen nt
  s_add_u32 s25, s25, 8192
  s_and_b32 s25, s25, 0x3ffff
  s_add_u32 s24, s64, s25
  buffer_load_dwordx4 v[196:199], v5, s[8:11], s24 offen nt
  s_add_u32 s25, s25, 8192
  s_and_b32 s25, s25, 0x3ffff
  s_add_u32 s24, s64, s25
  buffer_load_dwordx4 v[200:203], v5, s[8:11], s24 offen nt
  s_add_u32 s25, s25, 8192
  s_and_b32 s25, s25, 0x3ffff
  s_add_u32 s24, s64, s25
  buffer_load_dwordx4 v[204:207], v5, s[8:11], s24 offen nt
  s_add_u32 s25, s25, 8192
  s_and_b32 s25, s25, 0x3ffff
  s_add_u32 s24, s64, s25
  buffer_load_dwordx4 v[208:211], v5, s[8:11], s24 offen nt
  s_add_u32 s25, s25, 8192
  s_and_b32 s25, s25, 0x3ffff
  s_add_u32 s24, s64, s25
  buffer_load_dwordx4 v[212:215], v5, s[8:11], s24 offen nt
  s_add_u32 s25, s25, 8192
  s_and_b32 s25, s25, 0x3ffff
  s_add_u32 s24, s64, s25
  buffer_load_dwordx4 v[216:219], v5, s[8:11], s24 offen nt
  s_add_u32 s25, s25, 8192
  s_and_b32 s25, s25, 0x3ffff
  s_add_u32 s24, s64, s25
  buffer_load_dwordx4 v[220:223], v5, s[8:11], s24 offen nt
  s_add_u32 s25, s25, 8192
  s_and_b32 s25, s25, 0x3ffff
  s_add_u32 s24, s64, s25
  buffer_load_dwordx4 v[224:227], v5, s[8:11], s24 offen nt
  s_add_u32 s25, s25, 8192
  s_and_b32 s25, s25, 0x3ffff
  s_add_u32 s24, s64, s25
  buffer_load_dwordx4 v[228:231], v5, s[8:11], s24 offen nt
  s_add_u32 s25, s25, 8192
  s_and_b32 s25, s25, 0x3ffff
  s_add_u32 s24, s64, s25
  buffer_load_dwordx4 v[232:235], v5, s[8:11], s24 offen nt
  s_add_u32 s25, s25, 8192
  s_and_b32 s25, s25, 0x3ffff
  s_add_u32 s24, s64, s25
  buffer_load_dwordx4 v[236:239], v5, s[8:11], s24 offen nt
  s_add_u32 s25, s25, 8192
  s_and_b32 s25, s25, 0x3ffff
  s_add_u32 s24, s64, s25
  buffer_load_dwordx4 v[240:243], v5, s[8:11], s24 offen nt
  s_add_u32 s25, s25, 8192
  s_and_b32 s25, s25, 0x3ffff
  s_add_u32 s24, s64, s25
  buffer_load_dwordx4 v[244:247], v5, s[8:11], s24 offen nt
  s_add_u32 s25, s25, 8192
  s_and_b32 s25, s25, 0x3ffff
  s_add_u32 s24, s64, s25
  buffer_load_dwordx4 v[248:251], v5, s[8:11], s24 offen nt
  s_add_u32 s25, s25, 8192
  s_and_b32 s25, s25, 0x3ffff
  s_add_u32 s24, s64, s25
  buffer_load_dwordx4 v[252:255], v5, s[8:11], s24 offen nt
  s_cmp_lg_u32 s3, 0
  s_cbranch_scc1 L_noz2
  v_mov_b32 v28, 153088
  v_lshl_add_u32 v28, v4, 2, v28
  v_mov_b32 v29, 0
  ds_write_b32 v28, v29
L_noz2:
  v_and_b32 v28, 1, v1
  v_lshlrev_b32 v28, 4, v28
  v_mov_b32 v29, 0xffff
  v_lshlrev_b32 v28, v28, v29
  v_lshrrev_b32 v29, 1, v1
  v_cmp_eq_u32 vcc, 0, v29
  s_nop 1
  v_cndmask_b32 v16, 0, v28, vcc
  v_cmp_eq_u32 vcc, 1, v29
  s_nop 1
  v_cndmask_b32 v17, 0, v28, vcc
  v_cmp_eq_u32 vcc, 2, v29
  s_nop 1
  v_cndmask_b32 v18, 0, v28, vcc
  v_cmp_eq_u32 vcc, 3, v29
  s_nop 1
  v_cndmask_b32 v19, 0, v28, vcc
  v_mov_b32 v28, 0x0c0c0c0c
  s_mov_b32 s24, 0x01000100
  s_mov_b32 s25, 0x03020302
  v_bfi_b32 v8, v16, s24, v28
  v_bfi_b32 v12, v16, s25, v28
  v_bfi_b32 v9, v17, s24, v28
  v_bfi_b32 v13, v17, s25, v28
  v_bfi_b32 v10, v18, s24, v28
  v_bfi_b32 v14, v18, s25, v28
  v_bfi_b32 v11, v19, s24, v28
  v_bfi_b32 v15, v19, s25, v28
  s_waitcnt vmcnt(28)
  v_perm_b32 v16, v112, v112, v8
  v_perm_b32 v17, v112, v112, v9
  v_perm_b32 v18, v112, v112, v10
  v_perm_b32 v19, v112, v112, v11
  s_nop 1
  v_mfma_f32_16x16x32_bf16 v[24:27], v[128:131], v[16:19], 0
  v_perm_b32 v20, v112, v112, v12
  v_perm_b32 v21, v112, v112, v13
  v_perm_b32 v22, v112, v112, v14
  v_perm_b32 v23, v112, v112, v15
  s_nop 1
  v_mfma_f32_16x16x32_bf16 v[24:27], v[132:135], v[20:23], v[24:27]
  v_perm_b32 v16, v113, v113, v8
  v_perm_b32 v17, v113, v113, v9
  v_perm_b32 v18, v113, v113, v10
  v_perm_b32 v19, v113, v113, v11
  s_nop 1
  v_mfma_f32_16x16x32_bf16 v[24:27], v[136:139], v[16:19], v[24:27]
  v_perm_b32 v20, v113, v113, v12
  v_perm_b32 v21, v113, v113, v13
  v_perm_b32 v22, v113, v113, v14
  v_perm_b32 v23, v113, v113, v15
  s_nop 1
  v_mfma_f32_16x16x32_bf16 v[24:27], v[140:143], v[20:23], v[24:27]
  s_waitcnt vmcnt(24)
  v_perm_b32 v16, v114, v114, v8
  v_perm_b32 v17, v114, v114, v9
  v_perm_b32 v18, v114, v114, v10
  v_perm_b32 v19, v114, v114, v11
  s_nop 1
  v_mfma_f32_16x16x32_bf16 v[24:27], v[144:147], v[16:19], v[24:27]
  v_perm_b32 v20, v114, v114, v12
  v_perm_b32 v21, v114, v114, v13
  v_perm_b32 v22, v114, v114, v14
  v_perm_b32 v23, v114, v114, v15
  s_nop 1
  v_mfma_f32_16x16x32_bf16 v[24:27], v[148:151], v[20:23], v[24:27]
  v_perm_b32 v16, v115, v115, v8
  v_perm_b32 v17, v115, v115, v9
  v_perm_b32 v18, v115, v115, v10
  v_perm_b32 v19, v115, v115, v11
  s_nop 1
  v_mfma_f32_16x16x32_bf16 v[24:27], v[152:155], v[16:19], v[24:27]
  v_perm_b32 v20, v115, v115, v12
  v_perm_b32 v21, v115, v115, v13
  v_perm_b32 v22, v115, v115, v14
  v_perm_b32 v23, v115, v115, v15
  s_nop 1
  v_mfma_f32_16x16x32_bf16 v[24:27], v[156:159], v[20:23], v[24:27]
  s_waitcnt vmcnt(20)
  v_perm_b32 v16, v116, v116, v8
  v_perm_b32 v17, v116, v116, v9
  v_perm_b32 v18, v116, v116, v10
  v_perm_b32 v19, v116, v116, v11
  s_nop 1
  v_mfma_f32_16x16x32_bf16 v[24:27], v[160:163], v[16:19], v[24:27]
  v_perm_b32 v20, v116, v116, v12
  v_perm_b32 v21, v116, v116, v13
  v_perm_b32 v22, v116, v116, v14
  v_perm_b32 v23, v116, v116, v15
  s_nop 1
  v_mfma_f32_16x16x32_bf16 v[24:27], v[164:167], v[20:23], v[24:27]
  v_perm_b32 v16, v117, v117, v8
  v_perm_b32 v17, v117, v117, v9
  v_perm_b32 v18, v117, v117, v10
  v_perm_b32 v19, v117, v117, v11
  s_nop 1
  v_mfma_f32_16x16x32_bf16 v[24:27], v[168:171], v[16:19], v[24:27]
  v_perm_b32 v20, v117, v117, v12
  v_perm_b32 v21, v117, v117, v13
  v_perm_b32 v22, v117, v117, v14
  v_perm_b32 v23, v117, v117, v15
  s_nop 1
  v_mfma_f32_16x16x32_bf16 v[24:27], v[172:175], v[20:23], v[24:27]
  s_waitcnt vmcnt(16)
  v_perm_b32 v16, v118, v118, v8
  v_perm_b32 v17, v118, v118, v9
  v_perm_b32 v18, v118, v118, v10
  v_perm_b32 v19, v118, v118, v11
  s_nop 1
  v_mfma_f32_16x16x32_bf16 v[24:27], v[176:179], v[16:19], v[24:27]
  v_perm_b32 v20, v118, v118, v12
  v_perm_b32 v21, v118, v118, v13
  v_perm_b32 v22, v118, v118, v14
  v_perm_b32 v23, v118, v118, v15
  s_nop 1
  v_mfma_f32_16x16x32_bf16 v[24:27], v[180:183], v[20:23], v[24:27]
  v_perm_b32 v16, v119, v119, v8
  v_perm_b32 v17, v119, v119, v9
  v_perm_b32 v18, v119, v119, v10
  v_perm_b32 v19, v119, v119, v11
  s_nop 1
  v_mfma_f32_16x16x32_bf16 v[24:27], v[184:187], v[16:19], v[24:27]
  v_perm_b32 v20, v119, v119, v12
  v_perm_b32 v21, v119, v119, v13
  v_perm_b32 v22, v119, v119, v14
  v_perm_b32 v23, v119, v119, v15
  s_nop 1
  v_mfma_f32_16x16x32_bf16 v[24:27], v[188:191], v[20:23], v[24:27]
  s_waitcnt vmcnt(12)
  v_perm_b32 v16, v120, v120, v8
  v_perm_b32 v17, v120, v120, v9
  v_perm_b32 v18, v120, v120, v10
  v_perm_b32 v19, v120, v120, v11
  s_nop 1
  v_mfma_f32_16x16x32_bf16 v[24:27], v[192:195], v[16:19], v[24:27]
  v_perm_b32 v20, v120, v120, v12
  v_perm_b32 v21, v120, v120, v13
  v_perm_b32 v22, v120, v120, v14
  v_perm_b32 v23, v120, v120, v15
  s_nop 1
  v_mfma_f32_16x16x32_bf16 v[24:27], v[196:199], v[20:23], v[24:27]
  v_perm_b32 v16, v121, v121, v8
  v_perm_b32 v17, v121, v121, v9
  v_perm_b32 v18, v121, v121, v10
  v_perm_b32 v19, v121, v121, v11
  s_nop 1
  v_mfma_f32_16x16x32_bf16 v[24:27], v[200:203], v[16:19], v[24:27]
  v_perm_b32 v20, v121, v121, v12
  v_perm_b32 v21, v121, v121, v13
  v_perm_b32 v22, v121, v121, v14
  v_perm_b32 v23, v121, v121, v15
  s_nop 1
  v_mfma_f32_16x16x32_bf16 v[24:27], v[204:207], v[20:23], v[24:27]
  s_waitcnt vmcnt(8)
  v_perm_b32 v16, v122, v122, v8
  v_perm_b32 v17, v122, v122, v9
  v_perm_b32 v18, v122, v122, v10
  v_perm_b32 v19, v122, v122, v11
  s_nop 1
  v_mfma_f32_16x16x32_bf16 v[24:27], v[208:211], v[16:19], v[24:27]
  v_perm_b32 v20, v122, v122, v12
  v_perm_b32 v21, v122, v122, v13
  v_perm_b32 v22, v122, v122, v14
  v_perm_b32 v23, v122, v122, v15
  s_nop 1
  v_mfma_f32_16x16x32_bf16 v[24:27], v[212:215], v[20:23], v[24:27]
  v_perm_b32 v16, v123, v123, v8
  v_perm_b32 v17, v123, v123, v9
  v_perm_b32 v18, v123, v123, v10
  v_perm_b32 v19, v123, v123, v11
  s_nop 1
  v_mfma_f32_16x16x32_bf16 v[24:27], v[216:219], v[16:19], v[24:27]
  v_perm_b32 v20, v123, v123, v12
  v_perm_b32 v21, v123, v123, v13
  v_perm_b32 v22, v123, v123, v14
  v_perm_b32 v23, v123, v123, v15
  s_nop 1
  v_mfma_f32_16x16x32_bf16 v[24:27], v[220:223], v[20:23], v[24:27]
  s_waitcnt vmcnt(4)
  v_perm_b32 v16, v124, v124, v8
  v_perm_b32 v17, v124, v124, v9
  v_perm_b32 v18, v124, v124, v10
  v_perm_b32 v19, v124, v124, v11
  s_nop 1
  v_mfma_f32_16x16x32_bf16 v[24:27], v[224:227], v[16:19], v[24:27]
  v_perm_b32 v20, v124, v124, v12
  v_perm_b32 v21, v124, v124, v13
  v_perm_b32 v22, v124, v124, v14
  v_perm_b32 v23, v124, v124, v15
  s_nop 1
  v_mfma_f32_16x16x32_bf16 v[24:27], v[228:231], v[20:23], v[24:27]
  v_perm_b32 v16, v125, v125, v8
  v_perm_b32 v17, v125, v125, v9
  v_perm_b32 v18, v125, v125, v10
  v_perm_b32 v19, v125, v125, v11
  s_nop 1
  v_mfma_f32_16x16x32_bf16 v[24:27], v[232:235], v[16:19], v[24:27]
  v_perm_b32 v20, v125, v125, v12
  v_perm_b32 v21, v125, v125, v13
  v_perm_b32 v22, v125, v125, v14
  v_perm_b32 v23, v125, v125, v15
  s_nop 1
  v_mfma_f32_16x16x32_bf16 v[24:27], v[236:239], v[20:23], v[24:27]
  s_waitcnt vmcnt(0)
  v_perm_b32 v16, v126, v126, v8
  v_perm_b32 v17, v126, v126, v9
  v_perm_b32 v18, v126, v126, v10
  v_perm_b32 v19, v126, v126, v11
  s_nop 1
  v_mfma_f32_16x16x32_bf16 v[24:27], v[240:243], v[16:19], v[24:27]
  v_perm_b32 v20, v126, v126, v12
  v_perm_b32 v21, v126, v126, v13
  v_perm_b32 v22, v126, v126, v14
  v_perm_b32 v23, v126, v126, v15
  s_nop 1
  v_mfma_f32_16x16x32_bf16 v[24:27], v[244:247], v[20:23], v[24:27]
  v_perm_b32 v16, v127, v127, v8
  v_perm_b32 v17, v127, v127, v9
  v_perm_b32 v18, v127, v127, v10
  v_perm_b32 v19, v127, v127, v11
  s_nop 1
  v_mfma_f32_16x16x32_bf16 v[24:27], v[248:251], v[16:19], v[24:27]
  v_perm_b32 v20, v127, v127, v12
  v_perm_b32 v21, v127, v127, v13
  v_perm_b32 v22, v127, v127, v14
  v_perm_b32 v23, v127, v127, v15
  s_nop 1
  v_mfma_f32_16x16x32_bf16 v[24:27], v[252:255], v[20:23], v[24:27]
  v_lshlrev_b32 v30, 1, v7
  v_lshl_add_u32 v30, v1, 2, v30
  s_lshl_b32 s24, s63, 10
  s_add_u32 s24, s24, 135168
  v_add_u32 v30, s24, v30
  s_nop 2
  ds_write_b32 v30, v24 offset:0
  ds_write_b32 v30, v25 offset:32
  ds_write_b32 v30, v26 offset:64
  ds_write_b32 v30, v27 offset:96
  s_waitcnt lgkmcnt(0)
  s_barrier
  s_add_u32 s7, s7, 0x9e3779b1
  s_setprio 0
  v_mov_b32 v29, 153112
  s_mov_b32 s30, 50000
L_lp9:
  ds_read_b32 v28, v29
  s_waitcnt lgkmcnt(0)
  v_readfirstlane_b32 s31, v28
  s_cmp_ge_u32 s31, 4
  s_cbranch_scc1 L_lpd10
  s_sleep 4
  s_sub_u32 s30, s30, 1
  s_cmp_lg_u32 s30, 0
  s_cbranch_scc1 L_lp9
L_lpd10:
  s_branch L_b2in
L_tail:
  v_lshlrev_b32 v6, 15, v3
  v_lshl_add_u32 v6, v4, 4, v6
  v_lshrrev_b32 v47, 3, v4
  v_lshlrev_b32 v7, 8, v47
  v_lshl_add_u32 v7, v3, 6, v7
  v_lshlrev_b32 v47, 7, v47
  v_lshl_add_u32 v47, v1, 4, v47
  v_lshl_add_u32 v47, v3, 14, v47
  s_lshl_b32 s77, s63, 16
  s_add_u32 s77, s77, s65
  s_add_u32 s77, s77, 1835008
  s_cmp_lt_u32 s2, 32
  s_cselect_b32 s12, s40, s52
  s_cselect_b32 s13, s41, s53
  s_mov_b32 s14, 0x400000
  s_mov_b32 s15, 0x20000
  s_mov_b32 s24, s86
  buffer_load_dwordx4 v[128:131], v6, s[12:15], s24 offen offset:0 nt
  buffer_load_dwordx4 v[132:135], v6, s[12:15], s24 offen offset:1024 nt
  buffer_load_dwordx4 v[136:139], v6, s[12:15], s24 offen offset:2048 nt
  buffer_load_dwordx4 v[140:143], v6, s[12:15], s24 offen offset:3072 nt
  s_add_u32 s24, s24, 4096
  buffer_load_dwordx4 v[144:147], v6, s[12:15], s24 offen offset:0 nt
  buffer_load_dwordx4 v[148:151], v6, s[12:15], s24 offen offset:1024 nt
  buffer_load_dwordx4 v[152:155], v6, s[12:15], s24 offen offset:2048 nt
  buffer_load_dwordx4 v[156:159], v6, s[12:15], s24 offen offset:3072 nt
  s_add_u32 s24, s24, 4096
  buffer_load_dwordx4 v[160:163], v6, s[12:15], s24 offen offset:0 nt
  buffer_load_dwordx4 v[164:167], v6, s[12:15], s24 offen offset:1024 nt
  buffer_load_dwordx4 v[168:171], v6, s[12:15], s24 offen offset:2048 nt
  buffer_load_dwordx4 v[172:175], v6, s[12:15], s24 offen offset:3072 nt
  s_add_u32 s24, s24, 4096
  buffer_load_dwordx4 v[176:179], v6, s[12:15], s24 offen offset:0 nt
  buffer_load_dwordx4 v[180:183], v6, s[12:15], s24 offen offset:1024 nt
  buffer_load_dwordx4 v[184:187], v6, s[12:15], s24 offen offset:2048 nt
  buffer_load_dwordx4 v[188:191], v6, s[12:15], s24 offen offset:3072 nt
  s_add_u32 s24, s24, 4096
  buffer_load_dwordx4 v[192:195], v6, s[12:15], s24 offen offset:0 nt
  buffer_load_dwordx4 v[196:199], v6, s[12:15], s24 offen offset:1024 nt
  buffer_load_dwordx4 v[200:203], v6, s[12:15], s24 offen offset:2048 nt
  buffer_load_dwordx4 v[204:207], v6, s[12:15], s24 offen offset:3072 nt
  s_add_u32 s24, s24, 4096
  buffer_load_dwordx4 v[208:211], v6, s[12:15], s24 offen offset:0 nt
  buffer_load_dwordx4 v[212:215], v6, s[12:15], s24 offen offset:1024 nt
  buffer_load_dwordx4 v[216:219], v6, s[12:15], s24 offen offset:2048 nt
  buffer_load_dwordx4 v[220:223], v6, s[12:15], s24 offen offset:3072 nt
  s_add_u32 s24, s24, 4096
  buffer_load_dwordx4 v[224:227], v6, s[12:15], s24 offen offset:0 nt
  buffer_load_dwordx4 v[228:231], v6, s[12:15], s24 offen offset:1024 nt
  buffer_load_dwordx4 v[232:235], v6, s[12:15], s24 offen offset:2048 nt
  buffer_load_dwordx4 v[236:239], v6, s[12:15], s24 offen offset:3072 nt
  s_add_u32 s24, s24, 4096
  buffer_load_dwordx4 v[240:243], v6, s[12:15], s24 offen offset:0 nt
  buffer_load_dwordx4 v[244:247], v6, s[12:15], s24 offen offset:1024 nt
  buffer_load_dwordx4 v[248:251], v6, s[12:15], s24 offen offset:2048 nt
  buffer_load_dwordx4 v[252:255], v6, s[12:15], s24 offen offset:3072 nt
  v_and_b32 v28, 1, v1
  v_lshlrev_b32 v28, 4, v28
  v_mov_b32 v29, 0xffff
  v_lshlrev_b32 v28, v28, v29
  v_lshrrev_b32 v29, 1, v1
  v_cmp_eq_u32 vcc, 0, v29
  s_nop 1
  v_cndmask_b32 v16, 0, v28, vcc
  v_cmp_eq_u32 vcc, 1, v29
  s_nop 1
  v_cndmask_b32 v17, 0, v28, vcc
  v_cmp_eq_u32 vcc, 2, v29
  s_nop 1
  v_cndmask_b32 v18, 0, v28, vcc
  v_cmp_eq_u32 vcc, 3, v29
  s_nop 1
  v_cndmask_b32 v19, 0, v28, vcc
  v_mov_b32 v28, 0x0c0c0c0c
  s_mov_b32 s24, 0x01000100
  s_mov_b32 s25, 0x03020302
  v_bfi_b32 v8, v16, s24, v28
  v_bfi_b32 v12, v16, s25, v28
  v_bfi_b32 v9, v17, s24, v28
  v_bfi_b32 v13, v17, s25, v28
  v_bfi_b32 v10, v18, s24, v28
  v_bfi_b32 v14, v18, s25, v28
  v_bfi_b32 v11, v19, s24, v28
  v_bfi_b32 v15, v19, s25, v28
  s_cmp_lt_u32 s2, 32
  s_cbranch_scc1 L_ctail
  v_mov_b32 v29, 153100
  s_mov_b32 s30, 50000
L_lp11:
  ds_read_b32 v28, v29
  s_waitcnt lgkmcnt(0)
  v_readfirstlane_b32 s31, v28
  s_cmp_ge_u32 s31, 4
  s_cbranch_scc1 L_lpd12
  s_sleep 2
  s_sub_u32 s30, s30, 1
  s_cmp_lg_u32 s30, 0
  s_cbranch_scc1 L_lp11
L_lpd12:
  v_lshlrev_b32 v30, 1, v7
  v_add_u32 v30, 139264, v30
  ds_read_b128 v[48:51], v30 offset:0
  ds_read_b128 v[52:55], v30 offset:16
  ds_read_b128 v[56:59], v30 offset:32
  ds_read_b128 v[60:63], v30 offset:48
  ds_read_b128 v[64:67], v30 offset:64
  ds_read_b128 v[68:71], v30 offset:80
  ds_read_b128 v[72:75], v30 offset:96
  ds_read_b128 v[76:79], v30 offset:112
  ds_read_b128 v[80:83], v30 offset:1024
  ds_read_b128 v[84:87], v30 offset:1040
  ds_read_b128 v[88:91], v30 offset:1056
  ds_read_b128 v[92:95], v30 offset:1072
  ds_read_b128 v[96:99], v30 offset:1088
  ds_read_b128 v[100:103], v30 offset:1104
  ds_read_b128 v[104:107], v30 offset:1120
  ds_read_b128 v[108:111], v30 offset:1136
  s_waitcnt lgkmcnt(0)
  v_add_f32 v48, v48, v80
  v_add_f32 v49, v49, v81
  v_add_f32 v50, v50, v82
  v_add_f32 v51, v51, v83
  v_add_f32 v52, v52, v84
  v_add_f32 v53, v53, v85
  v_add_f32 v54, v54, v86
  v_add_f32 v55, v55, v87
  v_add_f32 v56, v56, v88
  v_add_f32 v57, v57, v89
  v_add_f32 v58, v58, v90
  v_add_f32 v59, v59, v91
  v_add_f32 v60, v60, v92
  v_add_f32 v61, v61, v93
  v_add_f32 v62, v62, v94
  v_add_f32 v63, v63, v95
  v_add_f32 v64, v64, v96
  v_add_f32 v65, v65, v97
  v_add_f32 v66, v66, v98
  v_add_f32 v67, v67, v99
  v_add_f32 v68, v68, v100
  v_add_f32 v69, v69, v101
  v_add_f32 v70, v70, v102
  v_add_f32 v71, v71, v103
  v_add_f32 v72, v72, v104
  v_add_f32 v73, v73, v105
  v_add_f32 v74, v74, v106
  v_add_f32 v75, v75, v107
  v_add_f32 v76, v76, v108
  v_add_f32 v77, v77, v109
  v_add_f32 v78, v78, v110
  v_add_f32 v79, v79, v111
  ds_read_b128 v[80:83], v30 offset:2048
  ds_read_b128 v[84:87], v30 offset:2064
  ds_read_b128 v[88:91], v30 offset:2080
  ds_read_b128 v[92:95], v30 offset:2096
  ds_read_b128 v[96:99], v30 offset:2112
  ds_read_b128 v[100:103], v30 offset:2128
  ds_read_b128 v[104:107], v30 offset:2144
  ds_read_b128 v[108:111], v30 offset:2160
  s_waitcnt lgkmcnt(0)
  v_add_f32 v48, v48, v80
  v_add_f32 v49, v49, v81
  v_add_f32 v50, v50, v82
  v_add_f32 v51, v51, v83
  v_add_f32 v52, v52, v84
  v_add_f32 v53, v53, v85
  v_add_f32 v54, v54, v86
  v_add_f32 v55, v55, v87
  v_add_f32 v56, v56, v88
  v_add_f32 v57, v57, v89
  v_add_f32 v58, v58, v90
  v_add_f32 v59, v59, v91
  v_add_f32 v60, v60, v92
  v_add_f32 v61, v61, v93
  v_add_f32 v62, v62, v94
  v_add_f32 v63, v63, v95
  v_add_f32 v64, v64, v96
  v_add_f32 v65, v65, v97
  v_add_f32 v66, v66, v98
  v_add_f32 v67, v67, v99
  v_add_f32 v68, v68, v100
  v_add_f32 v69, v69, v101
  v_add_f32 v70, v70, v102
  v_add_f32 v71, v71, v103
  v_add_f32 v72, v72, v104
  v_add_f32 v73, v73, v105
  v_add_f32 v74, v74, v106
  v_add_f32 v75, v75, v107
  v_add_f32 v76, v76, v108
  v_add_f32 v77, v77, v109
  v_add_f32 v78, v78, v110
  v_add_f32 v79, v79, v111
  ds_read_b128 v[80:83], v30 offset:3072
  ds_read_b128 v[84:87], v30 offset:3088
  ds_read_b128 v[88:91], v30 offset:3104
  ds_read_b128 v[92:95], v30 offset:3120
  ds_read_b128 v[96:99], v30 offset:3136
  ds_read_b128 v[100:103], v30 offset:3152
  ds_read_b128 v[104:107], v30 offset:3168
  ds_read_b128 v[108:111], v30 offset:3184
  s_waitcnt lgkmcnt(0)
  v_add_f32 v48, v48, v80
  v_add_f32 v49, v49, v81
  v_add_f32 v50, v50, v82
  v_add_f32 v51, v51, v83
  v_add_f32 v52, v52, v84
  v_add_f32 v53, v53, v85
  v_add_f32 v54, v54, v86
  v_add_f32 v55, v55, v87
  v_add_f32 v56, v56, v88
  v_add_f32 v57, v57, v89
  v_add_f32 v58, v58, v90
  v_add_f32 v59, v59, v91
  v_add_f32 v60, v60, v92
  v_add_f32 v61, v61, v93
  v_add_f32 v62, v62, v94
  v_add_f32 v63, v63, v95
  v_add_f32 v64, v64, v96
  v_add_f32 v65, v65, v97
  v_add_f32 v66, v66, v98
  v_add_f32 v67, v67, v99
  v_add_f32 v68, v68, v100
  v_add_f32 v69, v69, v101
  v_add_f32 v70, v70, v102
  v_add_f32 v71, v71, v103
  v_add_f32 v72, v72, v104
  v_add_f32 v73, v73, v105
  v_add_f32 v74, v74, v106
  v_add_f32 v75, v75, v107
  v_add_f32 v76, v76, v108
  v_add_f32 v77, v77, v109
  v_add_f32 v78, v78, v110
  v_add_f32 v79, v79, v111
  v_cvt_pk_bf16_f32 v112, v48, v49
  v_cvt_pk_bf16_f32 v113, v50, v51
  v_cvt_pk_bf16_f32 v114, v52, v53
  v_cvt_pk_bf16_f32 v115, v54, v55
  v_cvt_pk_bf16_f32 v116, v56, v57
  v_cvt_pk_bf16_f32 v117, v58, v59
  v_cvt_pk_bf16_f32 v118, v60, v61
  v_cvt_pk_bf16_f32 v119, v62, v63
  v_cvt_pk_bf16_f32 v120, v64, v65
  v_cvt_pk_bf16_f32 v121, v66, v67
  v_cvt_pk_bf16_f32 v122, v68, v69
  v_cvt_pk_bf16_f32 v123, v70, v71
  v_cvt_pk_bf16_f32 v124, v72, v73
  v_cvt_pk_bf16_f32 v125, v74, v75
  v_cvt_pk_bf16_f32 v126, v76, v77
  v_cvt_pk_bf16_f32 v127, v78, v79
  s_branch L_gpub
L_ctail:
  s_add_u32 s77, s77, 262144
  s_lshl_b32 s71, s5, 14
  s_lshl_b32 s24, s63, 12
  s_add_u32 s71, s71, s24
  s_add_u32 s71, s71, 1310720
  v_lshlrev_b32 v46, 4, v3
  v_and_b32 v44, 1, v4
  v_lshlrev_b32 v44, 5, v44
  v_and_b32 v43, 14, v4
  v_add_u32 v44, v44, v43
  s_lshl_b32 s24, s63, 6
  s_add_u32 s24, s24, 147456
  v_add_u32 v44, s24, v44
  s_mov_b32 s30, 50000
L_gp13:
  buffer_load_dwordx4 v[48:51], v2, s[16:19], s71 offen offset:0 sc1
  buffer_load_dwordx4 v[52:55], v46, s[16:19], s71 offen offset:2048 sc1
  buffer_load_dwordx4 v[56:59], v2, s[16:19], s71 offen offset:1024 sc1
  buffer_load_dwordx4 v[60:63], v46, s[16:19], s71 offen offset:2112 sc1
  s_waitcnt vmcnt(0)
  v_mov_b32 v28, v49
  v_mov_b32 v29, v49
  v_min3_u32 v28, v28, v51, v53
  v_max3_u32 v29, v29, v51, v53
  v_min3_u32 v28, v28, v55, v57
  v_max3_u32 v29, v29, v55, v57
  v_min3_u32 v28, v28, v59, v61
  v_max3_u32 v29, v29, v59, v61
  v_min3_u32 v28, v28, v63, v63
  v_max3_u32 v29, v29, v63, v63
  v_cmp_eq_u32 s[24:25], s7, v28
  v_cmp_eq_u32 vcc, s7, v29
  s_and_b64 vcc, vcc, s[24:25]
  s_mov_b64 s[82:83], vcc
  v_mov_b32 v49, v52
  v_mov_b32 v51, v49
  s_nop 1
  v_permlane16_swap_b32 v49, v51
  v_max_f32 v49, v49, v51
  v_mov_b32 v51, v49
  s_nop 1
  v_permlane32_swap_b32 v49, v51
  v_max_f32 v49, v49, v51
  v_sub_f32 v52, v52, v49
  v_mul_f32 v52, 0x3fb8aa3b, v52
  v_exp_f32 v52, v52
  s_nop 0
  v_mul_f32 v54, v52, v54
  v_mul_f32 v48, v52, v48
  v_mul_f32 v50, v52, v50
  v_mov_b32 v51, v54
  s_nop 1
  v_permlane16_swap_b32 v54, v51
  v_add_f32 v54, v54, v51
  v_mov_b32 v51, v54
  s_nop 1
  v_permlane32_swap_b32 v54, v51
  v_add_f32 v54, v54, v51
  v_mov_b32 v51, v48
  s_nop 1
  v_permlane16_swap_b32 v48, v51
  v_add_f32 v48, v48, v51
  v_mov_b32 v51, v48
  s_nop 1
  v_permlane32_swap_b32 v48, v51
  v_add_f32 v48, v48, v51
  v_mov_b32 v51, v50
  s_nop 1
  v_permlane16_swap_b32 v50, v51
  v_add_f32 v50, v50, v51
  v_mov_b32 v51, v50
  s_nop 1
  v_permlane32_swap_b32 v50, v51
  v_add_f32 v50, v50, v51
  v_rcp_f32 v54, v54
  s_nop 0
  v_mul_f32 v48, v54, v48
  v_mul_f32 v50, v54, v50
  v_cvt_pk_bf16_f32 v48, v48, v50
  ds_write_b16 v44, v48 offset:0
  ds_write_b16_d16_hi v44, v48 offset:16
  v_mov_b32 v57, v60
  v_mov_b32 v59, v57
  s_nop 1
  v_permlane16_swap_b32 v57, v59
  v_max_f32 v57, v57, v59
  v_mov_b32 v59, v57
  s_nop 1
  v_permlane32_swap_b32 v57, v59
  v_max_f32 v57, v57, v59
  v_sub_f32 v60, v60, v57
  v_mul_f32 v60, 0x3fb8aa3b, v60
  v_exp_f32 v60, v60
  s_nop 0
  v_mul_f32 v62, v60, v62
  v_mul_f32 v56, v60, v56
  v_mul_f32 v58, v60, v58
  v_mov_b32 v59, v62
  s_nop 1
  v_permlane16_swap_b32 v62, v59
  v_add_f32 v62, v62, v59
  v_mov_b32 v59, v62
  s_nop 1
  v_permlane32_swap_b32 v62, v59
  v_add_f32 v62, v62, v59
  v_mov_b32 v59, v56
  s_nop 1
  v_permlane16_swap_b32 v56, v59
  v_add_f32 v56, v56, v59
  v_mov_b32 v59, v56
  s_nop 1
  v_permlane32_swap_b32 v56, v59
  v_add_f32 v56, v56, v59
  v_mov_b32 v59, v58
  s_nop 1
  v_permlane16_swap_b32 v58, v59
  v_add_f32 v58, v58, v59
  v_mov_b32 v59, v58
  s_nop 1
  v_permlane32_swap_b32 v58, v59
  v_add_f32 v58, v58, v59
  v_rcp_f32 v62, v62
  s_nop 0
  v_mul_f32 v56, v62, v56
  v_mul_f32 v58, v62, v58
  v_cvt_pk_bf16_f32 v56, v56, v58
  ds_write_b16 v44, v56 offset:256
  ds_write_b16_d16_hi v44, v56 offset:272
  s_cmp_eq_u64 s[82:83], -1
  s_cbranch_scc1 L_gpd14
  s_sleep 2
  s_sub_u32 s30, s30, 1
  s_cmp_lg_u32 s30, 0
  s_cbranch_scc1 L_gp13
L_gpd14:
  v_mov_b32 v29, 153104
  v_mov_b32 v28, 1
  s_waitcnt lgkmcnt(0)
  s_mov_b64 exec, 1
  ds_add_u32 v29, v28
  s_mov_b64 exec, -1
  s_mov_b32 s30, 50000
L_lp15:
  ds_read_b32 v28, v29
  s_waitcnt lgkmcnt(0)
  v_readfirstlane_b32 s31, v28
  s_cmp_ge_u32 s31, 4
  s_cbranch_scc1 L_lpd16
  s_sleep 1
  s_sub_u32 s30, s30, 1
  s_cmp_lg_u32 s30, 0
  s_cbranch_scc1 L_lp15
L_lpd16:
  v_add_u32 v30, 147456, v7
  ds_read_b128 v[112:115], v30 offset:0
  ds_read_b128 v[116:119], v30 offset:16
  ds_read_b128 v[120:123], v30 offset:32
  ds_read_b128 v[124:127], v30 offset:48
  s_waitcnt lgkmcnt(0)
L_gpub:
  s_waitcnt vmcnt(28)
  v_perm_b32 v16, v112, v112, v8
  v_perm_b32 v17, v112, v112, v9
  v_perm_b32 v18, v112, v112, v10
  v_perm_b32 v19, v112, v112, v11
  s_nop 1
  v_mfma_f32_16x16x32_bf16 v[24:27], v[128:131], v[16:19], 0
  v_perm_b32 v20, v112, v112, v12
  v_perm_b32 v21, v112, v112, v13
  v_perm_b32 v22, v112, v112, v14
  v_perm_b32 v23, v112, v112, v15
  s_nop 1
  v_mfma_f32_16x16x32_bf16 v[24:27], v[132:135], v[20:23], v[24:27]
  v_perm_b32 v16, v113, v113, v8
  v_perm_b32 v17, v113, v113, v9
  v_perm_b32 v18, v113, v113, v10
  v_perm_b32 v19, v113, v113, v11
  s_nop 1
  v_mfma_f32_16x16x32_bf16 v[24:27], v[136:139], v[16:19], v[24:27]
  v_perm_b32 v20, v113, v113, v12
  v_perm_b32 v21, v113, v113, v13
  v_perm_b32 v22, v113, v113, v14
  v_perm_b32 v23, v113, v113, v15
  s_nop 1
  v_mfma_f32_16x16x32_bf16 v[24:27], v[140:143], v[20:23], v[24:27]
  s_waitcnt vmcnt(24)
  v_perm_b32 v16, v114, v114, v8
  v_perm_b32 v17, v114, v114, v9
  v_perm_b32 v18, v114, v114, v10
  v_perm_b32 v19, v114, v114, v11
  s_nop 1
  v_mfma_f32_16x16x32_bf16 v[24:27], v[144:147], v[16:19], v[24:27]
  v_perm_b32 v20, v114, v114, v12
  v_perm_b32 v21, v114, v114, v13
  v_perm_b32 v22, v114, v114, v14
  v_perm_b32 v23, v114, v114, v15
  s_nop 1
  v_mfma_f32_16x16x32_bf16 v[24:27], v[148:151], v[20:23], v[24:27]
  v_perm_b32 v16, v115, v115, v8
  v_perm_b32 v17, v115, v115, v9
  v_perm_b32 v18, v115, v115, v10
  v_perm_b32 v19, v115, v115, v11
  s_nop 1
  v_mfma_f32_16x16x32_bf16 v[24:27], v[152:155], v[16:19], v[24:27]
  v_perm_b32 v20, v115, v115, v12
  v_perm_b32 v21, v115, v115, v13
  v_perm_b32 v22, v115, v115, v14
  v_perm_b32 v23, v115, v115, v15
  s_nop 1
  v_mfma_f32_16x16x32_bf16 v[24:27], v[156:159], v[20:23], v[24:27]
  s_waitcnt vmcnt(20)
  v_perm_b32 v16, v116, v116, v8
  v_perm_b32 v17, v116, v116, v9
  v_perm_b32 v18, v116, v116, v10
  v_perm_b32 v19, v116, v116, v11
  s_nop 1
  v_mfma_f32_16x16x32_bf16 v[24:27], v[160:163], v[16:19], v[24:27]
  v_perm_b32 v20, v116, v116, v12
  v_perm_b32 v21, v116, v116, v13
  v_perm_b32 v22, v116, v116, v14
  v_perm_b32 v23, v116, v116, v15
  s_nop 1
  v_mfma_f32_16x16x32_bf16 v[24:27], v[164:167], v[20:23], v[24:27]
  v_perm_b32 v16, v117, v117, v8
  v_perm_b32 v17, v117, v117, v9
  v_perm_b32 v18, v117, v117, v10
  v_perm_b32 v19, v117, v117, v11
  s_nop 1
  v_mfma_f32_16x16x32_bf16 v[24:27], v[168:171], v[16:19], v[24:27]
  v_perm_b32 v20, v117, v117, v12
  v_perm_b32 v21, v117, v117, v13
  v_perm_b32 v22, v117, v117, v14
  v_perm_b32 v23, v117, v117, v15
  s_nop 1
  v_mfma_f32_16x16x32_bf16 v[24:27], v[172:175], v[20:23], v[24:27]
  s_waitcnt vmcnt(16)
  v_perm_b32 v16, v118, v118, v8
  v_perm_b32 v17, v118, v118, v9
  v_perm_b32 v18, v118, v118, v10
  v_perm_b32 v19, v118, v118, v11
  s_nop 1
  v_mfma_f32_16x16x32_bf16 v[24:27], v[176:179], v[16:19], v[24:27]
  v_perm_b32 v20, v118, v118, v12
  v_perm_b32 v21, v118, v118, v13
  v_perm_b32 v22, v118, v118, v14
  v_perm_b32 v23, v118, v118, v15
  s_nop 1
  v_mfma_f32_16x16x32_bf16 v[24:27], v[180:183], v[20:23], v[24:27]
  v_perm_b32 v16, v119, v119, v8
  v_perm_b32 v17, v119, v119, v9
  v_perm_b32 v18, v119, v119, v10
  v_perm_b32 v19, v119, v119, v11
  s_nop 1
  v_mfma_f32_16x16x32_bf16 v[24:27], v[184:187], v[16:19], v[24:27]
  v_perm_b32 v20, v119, v119, v12
  v_perm_b32 v21, v119, v119, v13
  v_perm_b32 v22, v119, v119, v14
  v_perm_b32 v23, v119, v119, v15
  s_nop 1
  v_mfma_f32_16x16x32_bf16 v[24:27], v[188:191], v[20:23], v[24:27]
  s_waitcnt vmcnt(12)
  v_perm_b32 v16, v120, v120, v8
  v_perm_b32 v17, v120, v120, v9
  v_perm_b32 v18, v120, v120, v10
  v_perm_b32 v19, v120, v120, v11
  s_nop 1
  v_mfma_f32_16x16x32_bf16 v[24:27], v[192:195], v[16:19], v[24:27]
  v_perm_b32 v20, v120, v120, v12
  v_perm_b32 v21, v120, v120, v13
  v_perm_b32 v22, v120, v120, v14
  v_perm_b32 v23, v120, v120, v15
  s_nop 1
  v_mfma_f32_16x16x32_bf16 v[24:27], v[196:199], v[20:23], v[24:27]
  v_perm_b32 v16, v121, v121, v8
  v_perm_b32 v17, v121, v121, v9
  v_perm_b32 v18, v121, v121, v10
  v_perm_b32 v19, v121, v121, v11
  s_nop 1
  v_mfma_f32_16x16x32_bf16 v[24:27], v[200:203], v[16:19], v[24:27]
  v_perm_b32 v20, v121, v121, v12
  v_perm_b32 v21, v121, v121, v13
  v_perm_b32 v22, v121, v121, v14
  v_perm_b32 v23, v121, v121, v15
  s_nop 1
  v_mfma_f32_16x16x32_bf16 v[24:27], v[204:207], v[20:23], v[24:27]
  s_waitcnt vmcnt(8)
  v_perm_b32 v16, v122, v122, v8
  v_perm_b32 v17, v122, v122, v9
  v_perm_b32 v18, v122, v122, v10
  v_perm_b32 v19, v122, v122, v11
  s_nop 1
  v_mfma_f32_16x16x32_bf16 v[24:27], v[208:211], v[16:19], v[24:27]
  v_perm_b32 v20, v122, v122, v12
  v_perm_b32 v21, v122, v122, v13
  v_perm_b32 v22, v122, v122, v14
  v_perm_b32 v23, v122, v122, v15
  s_nop 1
  v_mfma_f32_16x16x32_bf16 v[24:27], v[212:215], v[20:23], v[24:27]
  v_perm_b32 v16, v123, v123, v8
  v_perm_b32 v17, v123, v123, v9
  v_perm_b32 v18, v123, v123, v10
  v_perm_b32 v19, v123, v123, v11
  s_nop 1
  v_mfma_f32_16x16x32_bf16 v[24:27], v[216:219], v[16:19], v[24:27]
  v_perm_b32 v20, v123, v123, v12
  v_perm_b32 v21, v123, v123, v13
  v_perm_b32 v22, v123, v123, v14
  v_perm_b32 v23, v123, v123, v15
  s_nop 1
  v_mfma_f32_16x16x32_bf16 v[24:27], v[220:223], v[20:23], v[24:27]
  s_waitcnt vmcnt(4)
  v_perm_b32 v16, v124, v124, v8
  v_perm_b32 v17, v124, v124, v9
  v_perm_b32 v18, v124, v124, v10
  v_perm_b32 v19, v124, v124, v11
  s_nop 1
  v_mfma_f32_16x16x32_bf16 v[24:27], v[224:227], v[16:19], v[24:27]
  v_perm_b32 v20, v124, v124, v12
  v_perm_b32 v21, v124, v124, v13
  v_perm_b32 v22, v124, v124, v14
  v_perm_b32 v23, v124, v124, v15
  s_nop 1
  v_mfma_f32_16x16x32_bf16 v[24:27], v[228:231], v[20:23], v[24:27]
  v_perm_b32 v16, v125, v125, v8
  v_perm_b32 v17, v125, v125, v9
  v_perm_b32 v18, v125, v125, v10
  v_perm_b32 v19, v125, v125, v11
  s_nop 1
  v_mfma_f32_16x16x32_bf16 v[24:27], v[232:235], v[16:19], v[24:27]
  v_perm_b32 v20, v125, v125, v12
  v_perm_b32 v21, v125, v125, v13
  v_perm_b32 v22, v125, v125, v14
  v_perm_b32 v23, v125, v125, v15
  s_nop 1
  v_mfma_f32_16x16x32_bf16 v[24:27], v[236:239], v[20:23], v[24:27]
  s_waitcnt vmcnt(0)
  v_perm_b32 v16, v126, v126, v8
  v_perm_b32 v17, v126, v126, v9
  v_perm_b32 v18, v126, v126, v10
  v_perm_b32 v19, v126, v126, v11
  s_nop 1
  v_mfma_f32_16x16x32_bf16 v[24:27], v[240:243], v[16:19], v[24:27]
  v_perm_b32 v20, v126, v126, v12
  v_perm_b32 v21, v126, v126, v13
  v_perm_b32 v22, v126, v126, v14
  v_perm_b32 v23, v126, v126, v15
  s_nop 1
  v_mfma_f32_16x16x32_bf16 v[24:27], v[244:247], v[20:23], v[24:27]
  v_perm_b32 v16, v127, v127, v8
  v_perm_b32 v17, v127, v127, v9
  v_perm_b32 v18, v127, v127, v10
  v_perm_b32 v19, v127, v127, v11
  s_nop 1
  v_mfma_f32_16x16x32_bf16 v[24:27], v[248:251], v[16:19], v[24:27]
  v_perm_b32 v20, v127, v127, v12
  v_perm_b32 v21, v127, v127, v13
  v_perm_b32 v22, v127, v127, v14
  v_perm_b32 v23, v127, v127, v15
  s_nop 1
  v_mfma_f32_16x16x32_bf16 v[24:27], v[252:255], v[20:23], v[24:27]
  v_mov_b32 v33, s7
  v_mov_b32 v35, s7
  v_mov_b32 v37, s7
  v_mov_b32 v39, s7
  s_nop 3
  v_mov_b32 v32, v24
  v_mov_b32 v34, v25
  v_mov_b32 v36, v26
  v_mov_b32 v38, v27
  s_add_u32 s78, s77, 8192
  buffer_store_dwordx4 v[32:35], v47, s[16:19], s77 offen sc1
  buffer_store_dwordx4 v[36:39], v47, s[16:19], s78 offen sc1
  s_cmp_lg_u32 s3, 0
  s_cbranch_scc1 L_fin6
  v_mov_b32 v29, 153108
  v_mov_b32 v28, 1
  s_waitcnt lgkmcnt(0)
  s_mov_b64 exec, 1
  ds_add_u32 v29, v28
  s_mov_b64 exec, -1
L_fin6:
  s_branch L_fin
L_setb:
  s_mov_b32 s8, s48
  s_mov_b32 s9, s49
  s_mov_b32 s10, 0x400000
  s_mov_b32 s11, 0x20000
  s_setprio 2
  s_mov_b32 s25, 0
  s_add_u32 s24, s64, s25
  buffer_load_dwordx4 v[128:131], v5, s[8:11], s24 offen nt
  s_add_u32 s25, s25, 8192
  s_and_b32 s25, s25, 0x3ffff
  s_add_u32 s24, s64, s25
  buffer_load_dwordx4 v[132:135], v5, s[8:11], s24 offen nt
  s_add_u32 s25, s25, 8192
  s_and_b32 s25, s25, 0x3ffff
  s_add_u32 s24, s64, s25
  buffer_load_dwordx4 v[136:139], v5, s[8:11], s24 offen nt
  s_add_u32 s25, s25, 8192
  s_and_b32 s25, s25, 0x3ffff
  s_add_u32 s24, s64, s25
  buffer_load_dwordx4 v[140:143], v5, s[8:11], s24 offen nt
  s_add_u32 s25, s25, 8192
  s_and_b32 s25, s25, 0x3ffff
  s_add_u32 s24, s64, s25
  buffer_load_dwordx4 v[144:147], v5, s[8:11], s24 offen nt
  s_add_u32 s25, s25, 8192
  s_and_b32 s25, s25, 0x3ffff
  s_add_u32 s24, s64, s25
  buffer_load_dwordx4 v[148:151], v5, s[8:11], s24 offen nt
  s_add_u32 s25, s25, 8192
  s_and_b32 s25, s25, 0x3ffff
  s_add_u32 s24, s64, s25
  buffer_load_dwordx4 v[152:155], v5, s[8:11], s24 offen nt
  s_add_u32 s25, s25, 8192
  s_and_b32 s25, s25, 0x3ffff
  s_add_u32 s24, s64, s25
  buffer_load_dwordx4 v[156:159], v5, s[8:11], s24 offen nt
  s_add_u32 s25, s25, 8192
  s_and_b32 s25, s25, 0x3ffff
  s_add_u32 s24, s64, s25
  buffer_load_dwordx4 v[160:163], v5, s[8:11], s24 offen nt
  s_add_u32 s25, s25, 8192
  s_and_b32 s25, s25, 0x3ffff
  s_add_u32 s24, s64, s25
  buffer_load_dwordx4 v[164:167], v5, s[8:11], s24 offen nt
  s_add_u32 s25, s25, 8192
  s_and_b32 s25, s25, 0x3ffff
  s_add_u32 s24, s64, s25
  buffer_load_dwordx4 v[168:171], v5, s[8:11], s24 offen nt
  s_add_u32 s25, s25, 8192
  s_and_b32 s25, s25, 0x3ffff
  s_add_u32 s24, s64, s25
  buffer_load_dwordx4 v[172:175], v5, s[8:11], s24 offen nt
  s_add_u32 s25, s25, 8192
  s_and_b32 s25, s25, 0x3ffff
  s_add_u32 s24, s64, s25
  buffer_load_dwordx4 v[176:179], v5, s[8:11], s24 offen nt
  s_add_u32 s25, s25, 8192
  s_and_b32 s25, s25, 0x3ffff
  s_add_u32 s24, s64, s25
  buffer_load_dwordx4 v[180:183], v5, s[8:11], s24 offen nt
  s_add_u32 s25, s25, 8192
  s_and_b32 s25, s25, 0x3ffff
  s_add_u32 s24, s64, s25
  buffer_load_dwordx4 v[184:187], v5, s[8:11], s24 offen nt
  s_add_u32 s25, s25, 8192
  s_and_b32 s25, s25, 0x3ffff
  s_add_u32 s24, s64, s25
  buffer_load_dwordx4 v[188:191], v5, s[8:11], s24 offen nt
  s_add_u32 s25, s25, 8192
  s_and_b32 s25, s25, 0x3ffff
  s_add_u32 s24, s64, s25
  buffer_load_dwordx4 v[192:195], v5, s[8:11], s24 offen nt
  s_add_u32 s25, s25, 8192
  s_and_b32 s25, s25, 0x3ffff
  s_add_u32 s24, s64, s25
  buffer_load_dwordx4 v[196:199], v5, s[8:11], s24 offen nt
  s_add_u32 s25, s25, 8192
  s_and_b32 s25, s25, 0x3ffff
  s_add_u32 s24, s64, s25
  buffer_load_dwordx4 v[200:203], v5, s[8:11], s24 offen nt
  s_add_u32 s25, s25, 8192
  s_and_b32 s25, s25, 0x3ffff
  s_add_u32 s24, s64, s25
  buffer_load_dwordx4 v[204:207], v5, s[8:11], s24 offen nt
  s_add_u32 s25, s25, 8192
  s_and_b32 s25, s25, 0x3ffff
  s_add_u32 s24, s64, s25
  buffer_load_dwordx4 v[208:211], v5, s[8:11], s24 offen nt
  s_add_u32 s25, s25, 8192
  s_and_b32 s25, s25, 0x3ffff
  s_add_u32 s24, s64, s25
  buffer_load_dwordx4 v[212:215], v5, s[8:11], s24 offen nt
  s_add_u32 s25, s25, 8192
  s_and_b32 s25, s25, 0x3ffff
  s_add_u32 s24, s64, s25
  buffer_load_dwordx4 v[216:219], v5, s[8:11], s24 offen nt
  s_add_u32 s25, s25, 8192
  s_and_b32 s25, s25, 0x3ffff
  s_add_u32 s24, s64, s25
  buffer_load_dwordx4 v[220:223], v5, s[8:11], s24 offen nt
  s_add_u32 s25, s25, 8192
  s_and_b32 s25, s25, 0x3ffff
  s_add_u32 s24, s64, s25
  buffer_load_dwordx4 v[224:227], v5, s[8:11], s24 offen nt
  s_add_u32 s25, s25, 8192
  s_and_b32 s25, s25, 0x3ffff
  s_add_u32 s24, s64, s25
  buffer_load_dwordx4 v[228:231], v5, s[8:11], s24 offen nt
  s_add_u32 s25, s25, 8192
  s_and_b32 s25, s25, 0x3ffff
  s_add_u32 s24, s64, s25
  buffer_load_dwordx4 v[232:235], v5, s[8:11], s24 offen nt
  s_add_u32 s25, s25, 8192
  s_and_b32 s25, s25, 0x3ffff
  s_add_u32 s24, s64, s25
  buffer_load_dwordx4 v[236:239], v5, s[8:11], s24 offen nt
  s_add_u32 s25, s25, 8192
  s_and_b32 s25, s25, 0x3ffff
  s_add_u32 s24, s64, s25
  buffer_load_dwordx4 v[240:243], v5, s[8:11], s24 offen nt
  s_add_u32 s25, s25, 8192
  s_and_b32 s25, s25, 0x3ffff
  s_add_u32 s24, s64, s25
  buffer_load_dwordx4 v[244:247], v5, s[8:11], s24 offen nt
  s_add_u32 s25, s25, 8192
  s_and_b32 s25, s25, 0x3ffff
  s_add_u32 s24, s64, s25
  buffer_load_dwordx4 v[248:251], v5, s[8:11], s24 offen nt
  s_add_u32 s25, s25, 8192
  s_and_b32 s25, s25, 0x3ffff
  s_add_u32 s24, s64, s25
  buffer_load_dwordx4 v[252:255], v5, s[8:11], s24 offen nt
  v_and_b32 v28, 1, v1
  v_lshlrev_b32 v28, 4, v28
  v_mov_b32 v29, 0xffff
  v_lshlrev_b32 v28, v28, v29
  v_lshrrev_b32 v29, 1, v1
  v_cmp_eq_u32 vcc, 0, v29
  s_nop 1
  v_cndmask_b32 v16, 0, v28, vcc
  v_cmp_eq_u32 vcc, 1, v29
  s_nop 1
  v_cndmask_b32 v17, 0, v28, vcc
  v_cmp_eq_u32 vcc, 2, v29
  s_nop 1
  v_cndmask_b32 v18, 0, v28, vcc
  v_cmp_eq_u32 vcc, 3, v29
  s_nop 1
  v_cndmask_b32 v19, 0, v28, vcc
  v_mov_b32 v28, 0x0c0c0c0c
  s_mov_b32 s24, 0x01000100
  s_mov_b32 s25, 0x03020302
  v_bfi_b32 v8, v16, s24, v28
  v_bfi_b32 v12, v16, s25, v28
  v_bfi_b32 v9, v17, s24, v28
  v_bfi_b32 v13, v17, s25, v28
  v_bfi_b32 v10, v18, s24, v28
  v_bfi_b32 v14, v18, s25, v28
  v_bfi_b32 v11, v19, s24, v28
  v_bfi_b32 v15, v19, s25, v28
  s_waitcnt lgkmcnt(0)
  s_barrier
  s_add_u32 s7, s7, 0x9e3779b1
  v_lshlrev_b32 v30, 5, v4
  v_add_u32 v30, 135168, v30
  ds_read_b128 v[48:51], v30 offset:0
  ds_read_b128 v[52:55], v30 offset:16
  ds_read_b128 v[56:59], v30 offset:1024
  ds_read_b128 v[60:63], v30 offset:1040
  ds_read_b128 v[64:67], v30 offset:2048
  ds_read_b128 v[68:71], v30 offset:2064
  ds_read_b128 v[72:75], v30 offset:3072
  ds_read_b128 v[76:79], v30 offset:3088
  ds_read_b128 v[80:83], v30 offset:512
  ds_read_b128 v[84:87], v30 offset:528
  ds_read_b128 v[88:91], v30 offset:1536
  ds_read_b128 v[92:95], v30 offset:1552
  ds_read_b128 v[96:99], v30 offset:2560
  ds_read_b128 v[100:103], v30 offset:2576
  ds_read_b128 v[104:107], v30 offset:3584
  ds_read_b128 v[108:111], v30 offset:3600
  s_waitcnt lgkmcnt(0)
  v_add_f32 v48, v48, v56
  v_add_f32 v64, v64, v72
  v_add_f32 v49, v49, v57
  v_add_f32 v65, v65, v73
  v_add_f32 v50, v50, v58
  v_add_f32 v66, v66, v74
  v_add_f32 v51, v51, v59
  v_add_f32 v67, v67, v75
  v_add_f32 v52, v52, v60
  v_add_f32 v68, v68, v76
  v_add_f32 v53, v53, v61
  v_add_f32 v69, v69, v77
  v_add_f32 v54, v54, v62
  v_add_f32 v70, v70, v78
  v_add_f32 v55, v55, v63
  v_add_f32 v71, v71, v79
  v_add_f32 v48, v48, v64
  v_add_f32 v49, v49, v65
  v_add_f32 v50, v50, v66
  v_add_f32 v51, v51, v67
  v_add_f32 v52, v52, v68
  v_add_f32 v53, v53, v69
  v_add_f32 v54, v54, v70
  v_add_f32 v55, v55, v71
  v_cvt_pk_bf16_f32 v32, v48, v49
  v_cvt_pk_bf16_f32 v33, v50, v51
  v_cvt_pk_bf16_f32 v34, v52, v53
  v_cvt_pk_bf16_f32 v35, v54, v55
  v_add_f32 v80, v80, v88
  v_add_f32 v96, v96, v104
  v_add_f32 v81, v81, v89
  v_add_f32 v97, v97, v105
  v_add_f32 v82, v82, v90
  v_add_f32 v98, v98, v106
  v_add_f32 v83, v83, v91
  v_add_f32 v99, v99, v107
  v_add_f32 v84, v84, v92
  v_add_f32 v100, v100, v108
  v_add_f32 v85, v85, v93
  v_add_f32 v101, v101, v109
  v_add_f32 v86, v86, v94
  v_add_f32 v102, v102, v110
  v_add_f32 v87, v87, v95
  v_add_f32 v103, v103, v111
  v_add_f32 v80, v80, v96
  v_add_f32 v81, v81, v97
  v_add_f32 v82, v82, v98
  v_add_f32 v83, v83, v99
  v_add_f32 v84, v84, v100
  v_add_f32 v85, v85, v101
  v_add_f32 v86, v86, v102
  v_add_f32 v87, v87, v103
  v_cvt_pk_bf16_f32 v36, v80, v81
  v_cvt_pk_bf16_f32 v37, v82, v83
  v_cvt_pk_bf16_f32 v38, v84, v85
  v_cvt_pk_bf16_f32 v39, v86, v87
  s_lshl_b32 s24, s5, 10
  s_add_u32 s24, s24, s27
  s_add_u32 s72, s24, 1114112
  s_add_u32 s73, s72, 32768
  v_lshlrev_b32 v31, 6, v3
  s_waitcnt vmcnt(0)
  v_dot2_f32_bf16 v48, v128, v32, 0
  v_dot2_f32_bf16 v49, v132, v32, 0
  v_dot2_f32_bf16 v50, v136, v32, 0
  v_dot2_f32_bf16 v51, v140, v32, 0
  v_dot2_f32_bf16 v52, v144, v32, 0
  v_dot2_f32_bf16 v53, v148, v32, 0
  v_dot2_f32_bf16 v54, v152, v32, 0
  v_dot2_f32_bf16 v55, v156, v32, 0
  v_dot2_f32_bf16 v48, v129, v33, v48
  v_dot2_f32_bf16 v49, v133, v33, v49
  v_dot2_f32_bf16 v50, v137, v33, v50
  v_dot2_f32_bf16 v51, v141, v33, v51
  v_dot2_f32_bf16 v52, v145, v33, v52
  v_dot2_f32_bf16 v53, v149, v33, v53
  v_dot2_f32_bf16 v54, v153, v33, v54
  v_dot2_f32_bf16 v55, v157, v33, v55
  v_dot2_f32_bf16 v48, v130, v34, v48
  v_dot2_f32_bf16 v49, v134, v34, v49
  v_dot2_f32_bf16 v50, v138, v34, v50
  v_dot2_f32_bf16 v51, v142, v34, v51
  v_dot2_f32_bf16 v52, v146, v34, v52
  v_dot2_f32_bf16 v53, v150, v34, v53
  v_dot2_f32_bf16 v54, v154, v34, v54
  v_dot2_f32_bf16 v55, v158, v34, v55
  v_dot2_f32_bf16 v48, v131, v35, v48
  v_dot2_f32_bf16 v49, v135, v35, v49
  v_dot2_f32_bf16 v50, v139, v35, v50
  v_dot2_f32_bf16 v51, v143, v35, v51
  v_dot2_f32_bf16 v52, v147, v35, v52
  v_dot2_f32_bf16 v53, v151, v35, v53
  v_dot2_f32_bf16 v54, v155, v35, v54
  v_dot2_f32_bf16 v55, v159, v35, v55
  v_dot2_f32_bf16 v56, v128, v36, 0
  v_dot2_f32_bf16 v57, v132, v36, 0
  v_dot2_f32_bf16 v58, v136, v36, 0
  v_dot2_f32_bf16 v59, v140, v36, 0
  v_dot2_f32_bf16 v60, v144, v36, 0
  v_dot2_f32_bf16 v61, v148, v36, 0
  v_dot2_f32_bf16 v62, v152, v36, 0
  v_dot2_f32_bf16 v63, v156, v36, 0
  v_dot2_f32_bf16 v56, v129, v37, v56
  v_dot2_f32_bf16 v57, v133, v37, v57
  v_dot2_f32_bf16 v58, v137, v37, v58
  v_dot2_f32_bf16 v59, v141, v37, v59
  v_dot2_f32_bf16 v60, v145, v37, v60
  v_dot2_f32_bf16 v61, v149, v37, v61
  v_dot2_f32_bf16 v62, v153, v37, v62
  v_dot2_f32_bf16 v63, v157, v37, v63
  v_dot2_f32_bf16 v56, v130, v38, v56
  v_dot2_f32_bf16 v57, v134, v38, v57
  v_dot2_f32_bf16 v58, v138, v38, v58
  v_dot2_f32_bf16 v59, v142, v38, v59
  v_dot2_f32_bf16 v60, v146, v38, v60
  v_dot2_f32_bf16 v61, v150, v38, v61
  v_dot2_f32_bf16 v62, v154, v38, v62
  v_dot2_f32_bf16 v63, v158, v38, v63
  v_dot2_f32_bf16 v56, v131, v39, v56
  v_dot2_f32_bf16 v57, v135, v39, v57
  v_dot2_f32_bf16 v58, v139, v39, v58
  v_dot2_f32_bf16 v59, v143, v39, v59
  v_dot2_f32_bf16 v60, v147, v39, v60
  v_dot2_f32_bf16 v61, v151, v39, v61
  v_dot2_f32_bf16 v62, v155, v39, v62
  v_dot2_f32_bf16 v63, v159, v39, v63
  v_add_f32_dpp v48, v48, v48 row_ror:8 row_mask:0xf bank_mask:0xf
  v_add_f32_dpp v49, v49, v49 row_ror:8 row_mask:0xf bank_mask:0xf
  v_add_f32_dpp v50, v50, v50 row_ror:8 row_mask:0xf bank_mask:0xf
  v_add_f32_dpp v51, v51, v51 row_ror:8 row_mask:0xf bank_mask:0xf
  v_add_f32_dpp v52, v52, v52 row_ror:8 row_mask:0xf bank_mask:0xf
  v_add_f32_dpp v53, v53, v53 row_ror:8 row_mask:0xf bank_mask:0xf
  v_add_f32_dpp v54, v54, v54 row_ror:8 row_mask:0xf bank_mask:0xf
  v_add_f32_dpp v55, v55, v55 row_ror:8 row_mask:0xf bank_mask:0xf
  v_add_f32_dpp v56, v56, v56 row_ror:8 row_mask:0xf bank_mask:0xf
  v_add_f32_dpp v57, v57, v57 row_ror:8 row_mask:0xf bank_mask:0xf
  v_add_f32_dpp v58, v58, v58 row_ror:8 row_mask:0xf bank_mask:0xf
  v_add_f32_dpp v59, v59, v59 row_ror:8 row_mask:0xf bank_mask:0xf
  v_add_f32_dpp v60, v60, v60 row_ror:8 row_mask:0xf bank_mask:0xf
  v_add_f32_dpp v61, v61, v61 row_ror:8 row_mask:0xf bank_mask:0xf
  v_add_f32_dpp v62, v62, v62 row_ror:8 row_mask:0xf bank_mask:0xf
  v_add_f32_dpp v63, v63, v63 row_ror:8 row_mask:0xf bank_mask:0xf
  v_add_f32_dpp v48, v48, v48 row_ror:4 row_mask:0xf bank_mask:0xf
  v_add_f32_dpp v49, v49, v49 row_ror:4 row_mask:0xf bank_mask:0xf
  v_add_f32_dpp v50, v50, v50 row_ror:4 row_mask:0xf bank_mask:0xf
  v_add_f32_dpp v51, v51, v51 row_ror:4 row_mask:0xf bank_mask:0xf
  v_add_f32_dpp v52, v52, v52 row_ror:4 row_mask:0xf bank_mask:0xf
  v_add_f32_dpp v53, v53, v53 row_ror:4 row_mask:0xf bank_mask:0xf
  v_add_f32_dpp v54, v54, v54 row_ror:4 row_mask:0xf bank_mask:0xf
  v_add_f32_dpp v55, v55, v55 row_ror:4 row_mask:0xf bank_mask:0xf
  v_add_f32_dpp v56, v56, v56 row_ror:4 row_mask:0xf bank_mask:0xf
  v_add_f32_dpp v57, v57, v57 row_ror:4 row_mask:0xf bank_mask:0xf
  v_add_f32_dpp v58, v58, v58 row_ror:4 row_mask:0xf bank_mask:0xf
  v_add_f32_dpp v59, v59, v59 row_ror:4 row_mask:0xf bank_mask:0xf
  v_add_f32_dpp v60, v60, v60 row_ror:4 row_mask:0xf bank_mask:0xf
  v_add_f32_dpp v61, v61, v61 row_ror:4 row_mask:0xf bank_mask:0xf
  v_add_f32_dpp v62, v62, v62 row_ror:4 row_mask:0xf bank_mask:0xf
  v_add_f32_dpp v63, v63, v63 row_ror:4 row_mask:0xf bank_mask:0xf
  v_add_f32_dpp v48, v48, v48 row_ror:2 row_mask:0xf bank_mask:0xf
  v_add_f32_dpp v49, v49, v49 row_ror:2 row_mask:0xf bank_mask:0xf
  v_add_f32_dpp v50, v50, v50 row_ror:2 row_mask:0xf bank_mask:0xf
  v_add_f32_dpp v51, v51, v51 row_ror:2 row_mask:0xf bank_mask:0xf
  v_add_f32_dpp v52, v52, v52 row_ror:2 row_mask:0xf bank_mask:0xf
  v_add_f32_dpp v53, v53, v53 row_ror:2 row_mask:0xf bank_mask:0xf
  v_add_f32_dpp v54, v54, v54 row_ror:2 row_mask:0xf bank_mask:0xf
  v_add_f32_dpp v55, v55, v55 row_ror:2 row_mask:0xf bank_mask:0xf
  v_add_f32_dpp v56, v56, v56 row_ror:2 row_mask:0xf bank_mask:0xf
  v_add_f32_dpp v57, v57, v57 row_ror:2 row_mask:0xf bank_mask:0xf
  v_add_f32_dpp v58, v58, v58 row_ror:2 row_mask:0xf bank_mask:0xf
  v_add_f32_dpp v59, v59, v59 row_ror:2 row_mask:0xf bank_mask:0xf
  v_add_f32_dpp v60, v60, v60 row_ror:2 row_mask:0xf bank_mask:0xf
  v_add_f32_dpp v61, v61, v61 row_ror:2 row_mask:0xf bank_mask:0xf
  v_add_f32_dpp v62, v62, v62 row_ror:2 row_mask:0xf bank_mask:0xf
  v_add_f32_dpp v63, v63, v63 row_ror:2 row_mask:0xf bank_mask:0xf
  v_add_f32_dpp v48, v48, v48 row_ror:1 row_mask:0xf bank_mask:0xf
  v_add_f32_dpp v49, v49, v49 row_ror:1 row_mask:0xf bank_mask:0xf
  v_add_f32_dpp v50, v50, v50 row_ror:1 row_mask:0xf bank_mask:0xf
  v_add_f32_dpp v51, v51, v51 row_ror:1 row_mask:0xf bank_mask:0xf
  v_add_f32_dpp v52, v52, v52 row_ror:1 row_mask:0xf bank_mask:0xf
  v_add_f32_dpp v53, v53, v53 row_ror:1 row_mask:0xf bank_mask:0xf
  v_add_f32_dpp v54, v54, v54 row_ror:1 row_mask:0xf bank_mask:0xf
  v_add_f32_dpp v55, v55, v55 row_ror:1 row_mask:0xf bank_mask:0xf
  v_add_f32_dpp v56, v56, v56 row_ror:1 row_mask:0xf bank_mask:0xf
  v_add_f32_dpp v57, v57, v57 row_ror:1 row_mask:0xf bank_mask:0xf
  v_add_f32_dpp v58, v58, v58 row_ror:1 row_mask:0xf bank_mask:0xf
  v_add_f32_dpp v59, v59, v59 row_ror:1 row_mask:0xf bank_mask:0xf
  v_add_f32_dpp v60, v60, v60 row_ror:1 row_mask:0xf bank_mask:0xf
  v_add_f32_dpp v61, v61, v61 row_ror:1 row_mask:0xf bank_mask:0xf
  v_add_f32_dpp v62, v62, v62 row_ror:1 row_mask:0xf bank_mask:0xf
  v_add_f32_dpp v63, v63, v63 row_ror:1 row_mask:0xf bank_mask:0xf
  v_cvt_pk_bf16_f32 v64, v48, v49
  v_cvt_pk_bf16_f32 v65, v50, v51
  v_cvt_pk_bf16_f32 v66, v52, v53
  v_cvt_pk_bf16_f32 v67, v54, v55
  v_cvt_pk_bf16_f32 v68, v56, v57
  v_cvt_pk_bf16_f32 v69, v58, v59
  v_cvt_pk_bf16_f32 v70, v60, v61
  v_cvt_pk_bf16_f32 v71, v62, v63
  s_mov_b32 exec_lo, 0x00010001
  s_mov_b32 exec_hi, 0x00010001
  buffer_store_dwordx4 v[64:67], v31, s[16:19], s72 offen offset:0 sc1
  buffer_store_dwordx4 v[68:71], v31, s[16:19], s73 offen offset:0 sc1
  s_mov_b64 exec, -1
  v_dot2_f32_bf16 v48, v160, v32, 0
  v_dot2_f32_bf16 v49, v164, v32, 0
  v_dot2_f32_bf16 v50, v168, v32, 0
  v_dot2_f32_bf16 v51, v172, v32, 0
  v_dot2_f32_bf16 v52, v176, v32, 0
  v_dot2_f32_bf16 v53, v180, v32, 0
  v_dot2_f32_bf16 v54, v184, v32, 0
  v_dot2_f32_bf16 v55, v188, v32, 0
  v_dot2_f32_bf16 v48, v161, v33, v48
  v_dot2_f32_bf16 v49, v165, v33, v49
  v_dot2_f32_bf16 v50, v169, v33, v50
  v_dot2_f32_bf16 v51, v173, v33, v51
  v_dot2_f32_bf16 v52, v177, v33, v52
  v_dot2_f32_bf16 v53, v181, v33, v53
  v_dot2_f32_bf16 v54, v185, v33, v54
  v_dot2_f32_bf16 v55, v189, v33, v55
  v_dot2_f32_bf16 v48, v162, v34, v48
  v_dot2_f32_bf16 v49, v166, v34, v49
  v_dot2_f32_bf16 v50, v170, v34, v50
  v_dot2_f32_bf16 v51, v174, v34, v51
  v_dot2_f32_bf16 v52, v178, v34, v52
  v_dot2_f32_bf16 v53, v182, v34, v53
  v_dot2_f32_bf16 v54, v186, v34, v54
  v_dot2_f32_bf16 v55, v190, v34, v55
  v_dot2_f32_bf16 v48, v163, v35, v48
  v_dot2_f32_bf16 v49, v167, v35, v49
  v_dot2_f32_bf16 v50, v171, v35, v50
  v_dot2_f32_bf16 v51, v175, v35, v51
  v_dot2_f32_bf16 v52, v179, v35, v52
  v_dot2_f32_bf16 v53, v183, v35, v53
  v_dot2_f32_bf16 v54, v187, v35, v54
  v_dot2_f32_bf16 v55, v191, v35, v55
  v_dot2_f32_bf16 v56, v160, v36, 0
  v_dot2_f32_bf16 v57, v164, v36, 0
  v_dot2_f32_bf16 v58, v168, v36, 0
  v_dot2_f32_bf16 v59, v172, v36, 0
  v_dot2_f32_bf16 v60, v176, v36, 0
  v_dot2_f32_bf16 v61, v180, v36, 0
  v_dot2_f32_bf16 v62, v184, v36, 0
  v_dot2_f32_bf16 v63, v188, v36, 0
  v_dot2_f32_bf16 v56, v161, v37, v56
  v_dot2_f32_bf16 v57, v165, v37, v57
  v_dot2_f32_bf16 v58, v169, v37, v58
  v_dot2_f32_bf16 v59, v173, v37, v59
  v_dot2_f32_bf16 v60, v177, v37, v60
  v_dot2_f32_bf16 v61, v181, v37, v61
  v_dot2_f32_bf16 v62, v185, v37, v62
  v_dot2_f32_bf16 v63, v189, v37, v63
  v_dot2_f32_bf16 v56, v162, v38, v56
  v_dot2_f32_bf16 v57, v166, v38, v57
  v_dot2_f32_bf16 v58, v170, v38, v58
  v_dot2_f32_bf16 v59, v174, v38, v59
  v_dot2_f32_bf16 v60, v178, v38, v60
  v_dot2_f32_bf16 v61, v182, v38, v61
  v_dot2_f32_bf16 v62, v186, v38, v62
  v_dot2_f32_bf16 v63, v190, v38, v63
  v_dot2_f32_bf16 v56, v163, v39, v56
  v_dot2_f32_bf16 v57, v167, v39, v57
  v_dot2_f32_bf16 v58, v171, v39, v58
  v_dot2_f32_bf16 v59, v175, v39, v59
  v_dot2_f32_bf16 v60, v179, v39, v60
  v_dot2_f32_bf16 v61, v183, v39, v61
  v_dot2_f32_bf16 v62, v187, v39, v62
  v_dot2_f32_bf16 v63, v191, v39, v63
  v_add_f32_dpp v48, v48, v48 row_ror:8 row_mask:0xf bank_mask:0xf
  v_add_f32_dpp v49, v49, v49 row_ror:8 row_mask:0xf bank_mask:0xf
  v_add_f32_dpp v50, v50, v50 row_ror:8 row_mask:0xf bank_mask:0xf
  v_add_f32_dpp v51, v51, v51 row_ror:8 row_mask:0xf bank_mask:0xf
  v_add_f32_dpp v52, v52, v52 row_ror:8 row_mask:0xf bank_mask:0xf
  v_add_f32_dpp v53, v53, v53 row_ror:8 row_mask:0xf bank_mask:0xf
  v_add_f32_dpp v54, v54, v54 row_ror:8 row_mask:0xf bank_mask:0xf
  v_add_f32_dpp v55, v55, v55 row_ror:8 row_mask:0xf bank_mask:0xf
  v_add_f32_dpp v56, v56, v56 row_ror:8 row_mask:0xf bank_mask:0xf
  v_add_f32_dpp v57, v57, v57 row_ror:8 row_mask:0xf bank_mask:0xf
  v_add_f32_dpp v58, v58, v58 row_ror:8 row_mask:0xf bank_mask:0xf
  v_add_f32_dpp v59, v59, v59 row_ror:8 row_mask:0xf bank_mask:0xf
  v_add_f32_dpp v60, v60, v60 row_ror:8 row_mask:0xf bank_mask:0xf
  v_add_f32_dpp v61, v61, v61 row_ror:8 row_mask:0xf bank_mask:0xf
  v_add_f32_dpp v62, v62, v62 row_ror:8 row_mask:0xf bank_mask:0xf
  v_add_f32_dpp v63, v63, v63 row_ror:8 row_mask:0xf bank_mask:0xf
  v_add_f32_dpp v48, v48, v48 row_ror:4 row_mask:0xf bank_mask:0xf
  v_add_f32_dpp v49, v49, v49 row_ror:4 row_mask:0xf bank_mask:0xf
  v_add_f32_dpp v50, v50, v50 row_ror:4 row_mask:0xf bank_mask:0xf
  v_add_f32_dpp v51, v51, v51 row_ror:4 row_mask:0xf bank_mask:0xf
  v_add_f32_dpp v52, v52, v52 row_ror:4 row_mask:0xf bank_mask:0xf
  v_add_f32_dpp v53, v53, v53 row_ror:4 row_mask:0xf bank_mask:0xf
  v_add_f32_dpp v54, v54, v54 row_ror:4 row_mask:0xf bank_mask:0xf
  v_add_f32_dpp v55, v55, v55 row_ror:4 row_mask:0xf bank_mask:0xf
  v_add_f32_dpp v56, v56, v56 row_ror:4 row_mask:0xf bank_mask:0xf
  v_add_f32_dpp v57, v57, v57 row_ror:4 row_mask:0xf bank_mask:0xf
  v_add_f32_dpp v58, v58, v58 row_ror:4 row_mask:0xf bank_mask:0xf
  v_add_f32_dpp v59, v59, v59 row_ror:4 row_mask:0xf bank_mask:0xf
  v_add_f32_dpp v60, v60, v60 row_ror:4 row_mask:0xf bank_mask:0xf
  v_add_f32_dpp v61, v61, v61 row_ror:4 row_mask:0xf bank_mask:0xf
  v_add_f32_dpp v62, v62, v62 row_ror:4 row_mask:0xf bank_mask:0xf
  v_add_f32_dpp v63, v63, v63 row_ror:4 row_mask:0xf bank_mask:0xf
  v_add_f32_dpp v48, v48, v48 row_ror:2 row_mask:0xf bank_mask:0xf
  v_add_f32_dpp v49, v49, v49 row_ror:2 row_mask:0xf bank_mask:0xf
  v_add_f32_dpp v50, v50, v50 row_ror:2 row_mask:0xf bank_mask:0xf
  v_add_f32_dpp v51, v51, v51 row_ror:2 row_mask:0xf bank_mask:0xf
  v_add_f32_dpp v52, v52, v52 row_ror:2 row_mask:0xf bank_mask:0xf
  v_add_f32_dpp v53, v53, v53 row_ror:2 row_mask:0xf bank_mask:0xf
  v_add_f32_dpp v54, v54, v54 row_ror:2 row_mask:0xf bank_mask:0xf
  v_add_f32_dpp v55, v55, v55 row_ror:2 row_mask:0xf bank_mask:0xf
  v_add_f32_dpp v56, v56, v56 row_ror:2 row_mask:0xf bank_mask:0xf
  v_add_f32_dpp v57, v57, v57 row_ror:2 row_mask:0xf bank_mask:0xf
  v_add_f32_dpp v58, v58, v58 row_ror:2 row_mask:0xf bank_mask:0xf
  v_add_f32_dpp v59, v59, v59 row_ror:2 row_mask:0xf bank_mask:0xf
  v_add_f32_dpp v60, v60, v60 row_ror:2 row_mask:0xf bank_mask:0xf
  v_add_f32_dpp v61, v61, v61 row_ror:2 row_mask:0xf bank_mask:0xf
  v_add_f32_dpp v62, v62, v62 row_ror:2 row_mask:0xf bank_mask:0xf
  v_add_f32_dpp v63, v63, v63 row_ror:2 row_mask:0xf bank_mask:0xf
  v_add_f32_dpp v48, v48, v48 row_ror:1 row_mask:0xf bank_mask:0xf
  v_add_f32_dpp v49, v49, v49 row_ror:1 row_mask:0xf bank_mask:0xf
  v_add_f32_dpp v50, v50, v50 row_ror:1 row_mask:0xf bank_mask:0xf
  v_add_f32_dpp v51, v51, v51 row_ror:1 row_mask:0xf bank_mask:0xf
  v_add_f32_dpp v52, v52, v52 row_ror:1 row_mask:0xf bank_mask:0xf
  v_add_f32_dpp v53, v53, v53 row_ror:1 row_mask:0xf bank_mask:0xf
  v_add_f32_dpp v54, v54, v54 row_ror:1 row_mask:0xf bank_mask:0xf
  v_add_f32_dpp v55, v55, v55 row_ror:1 row_mask:0xf bank_mask:0xf
  v_add_f32_dpp v56, v56, v56 row_ror:1 row_mask:0xf bank_mask:0xf
  v_add_f32_dpp v57, v57, v57 row_ror:1 row_mask:0xf bank_mask:0xf
  v_add_f32_dpp v58, v58, v58 row_ror:1 row_mask:0xf bank_mask:0xf
  v_add_f32_dpp v59, v59, v59 row_ror:1 row_mask:0xf bank_mask:0xf
  v_add_f32_dpp v60, v60, v60 row_ror:1 row_mask:0xf bank_mask:0xf
  v_add_f32_dpp v61, v61, v61 row_ror:1 row_mask:0xf bank_mask:0xf
  v_add_f32_dpp v62, v62, v62 row_ror:1 row_mask:0xf bank_mask:0xf
  v_add_f32_dpp v63, v63, v63 row_ror:1 row_mask:0xf bank_mask:0xf
  v_cvt_pk_bf16_f32 v72, v48, v49
  v_cvt_pk_bf16_f32 v73, v50, v51
  v_cvt_pk_bf16_f32 v74, v52, v53
  v_cvt_pk_bf16_f32 v75, v54, v55
  v_cvt_pk_bf16_f32 v76, v56, v57
  v_cvt_pk_bf16_f32 v77, v58, v59
  v_cvt_pk_bf16_f32 v78, v60, v61
  v_cvt_pk_bf16_f32 v79, v62, v63
  s_mov_b32 exec_lo, 0x00010001
  s_mov_b32 exec_hi, 0x00010001
  buffer_store_dwordx4 v[72:75], v31, s[16:19], s72 offen offset:16 sc1
  buffer_store_dwordx4 v[76:79], v31, s[16:19], s73 offen offset:16 sc1
  s_mov_b64 exec, -1
  v_dot2_f32_bf16 v48, v192, v32, 0
  v_dot2_f32_bf16 v49, v196, v32, 0
  v_dot2_f32_bf16 v50, v200, v32, 0
  v_dot2_f32_bf16 v51, v204, v32, 0
  v_dot2_f32_bf16 v52, v208, v32, 0
  v_dot2_f32_bf16 v53, v212, v32, 0
  v_dot2_f32_bf16 v54, v216, v32, 0
  v_dot2_f32_bf16 v55, v220, v32, 0
  v_dot2_f32_bf16 v48, v193, v33, v48
  v_dot2_f32_bf16 v49, v197, v33, v49
  v_dot2_f32_bf16 v50, v201, v33, v50
  v_dot2_f32_bf16 v51, v205, v33, v51
  v_dot2_f32_bf16 v52, v209, v33, v52
  v_dot2_f32_bf16 v53, v213, v33, v53
  v_dot2_f32_bf16 v54, v217, v33, v54
  v_dot2_f32_bf16 v55, v221, v33, v55
  v_dot2_f32_bf16 v48, v194, v34, v48
  v_dot2_f32_bf16 v49, v198, v34, v49
  v_dot2_f32_bf16 v50, v202, v34, v50
  v_dot2_f32_bf16 v51, v206, v34, v51
  v_dot2_f32_bf16 v52, v210, v34, v52
  v_dot2_f32_bf16 v53, v214, v34, v53
  v_dot2_f32_bf16 v54, v218, v34, v54
  v_dot2_f32_bf16 v55, v222, v34, v55
  v_dot2_f32_bf16 v48, v195, v35, v48
  v_dot2_f32_bf16 v49, v199, v35, v49
  v_dot2_f32_bf16 v50, v203, v35, v50
  v_dot2_f32_bf16 v51, v207, v35, v51
  v_dot2_f32_bf16 v52, v211, v35, v52
  v_dot2_f32_bf16 v53, v215, v35, v53
  v_dot2_f32_bf16 v54, v219, v35, v54
  v_dot2_f32_bf16 v55, v223, v35, v55
  v_dot2_f32_bf16 v56, v192, v36, 0
  v_dot2_f32_bf16 v57, v196, v36, 0
  v_dot2_f32_bf16 v58, v200, v36, 0
  v_dot2_f32_bf16 v59, v204, v36, 0
  v_dot2_f32_bf16 v60, v208, v36, 0
  v_dot2_f32_bf16 v61, v212, v36, 0
  v_dot2_f32_bf16 v62, v216, v36, 0
  v_dot2_f32_bf16 v63, v220, v36, 0
  v_dot2_f32_bf16 v56, v193, v37, v56
  v_dot2_f32_bf16 v57, v197, v37, v57
  v_dot2_f32_bf16 v58, v201, v37, v58
  v_dot2_f32_bf16 v59, v205, v37, v59
  v_dot2_f32_bf16 v60, v209, v37, v60
  v_dot2_f32_bf16 v61, v213, v37, v61
  v_dot2_f32_bf16 v62, v217, v37, v62
  v_dot2_f32_bf16 v63, v221, v37, v63
  v_dot2_f32_bf16 v56, v194, v38, v56
  v_dot2_f32_bf16 v57, v198, v38, v57
  v_dot2_f32_bf16 v58, v202, v38, v58
  v_dot2_f32_bf16 v59, v206, v38, v59
  v_dot2_f32_bf16 v60, v210, v38, v60
  v_dot2_f32_bf16 v61, v214, v38, v61
  v_dot2_f32_bf16 v62, v218, v38, v62
  v_dot2_f32_bf16 v63, v222, v38, v63
  v_dot2_f32_bf16 v56, v195, v39, v56
  v_dot2_f32_bf16 v57, v199, v39, v57
  v_dot2_f32_bf16 v58, v203, v39, v58
  v_dot2_f32_bf16 v59, v207, v39, v59
  v_dot2_f32_bf16 v60, v211, v39, v60
  v_dot2_f32_bf16 v61, v215, v39, v61
  v_dot2_f32_bf16 v62, v219, v39, v62
  v_dot2_f32_bf16 v63, v223, v39, v63
  v_add_f32_dpp v48, v48, v48 row_ror:8 row_mask:0xf bank_mask:0xf
  v_add_f32_dpp v49, v49, v49 row_ror:8 row_mask:0xf bank_mask:0xf
  v_add_f32_dpp v50, v50, v50 row_ror:8 row_mask:0xf bank_mask:0xf
  v_add_f32_dpp v51, v51, v51 row_ror:8 row_mask:0xf bank_mask:0xf
  v_add_f32_dpp v52, v52, v52 row_ror:8 row_mask:0xf bank_mask:0xf
  v_add_f32_dpp v53, v53, v53 row_ror:8 row_mask:0xf bank_mask:0xf
  v_add_f32_dpp v54, v54, v54 row_ror:8 row_mask:0xf bank_mask:0xf
  v_add_f32_dpp v55, v55, v55 row_ror:8 row_mask:0xf bank_mask:0xf
  v_add_f32_dpp v56, v56, v56 row_ror:8 row_mask:0xf bank_mask:0xf
  v_add_f32_dpp v57, v57, v57 row_ror:8 row_mask:0xf bank_mask:0xf
  v_add_f32_dpp v58, v58, v58 row_ror:8 row_mask:0xf bank_mask:0xf
  v_add_f32_dpp v59, v59, v59 row_ror:8 row_mask:0xf bank_mask:0xf
  v_add_f32_dpp v60, v60, v60 row_ror:8 row_mask:0xf bank_mask:0xf
  v_add_f32_dpp v61, v61, v61 row_ror:8 row_mask:0xf bank_mask:0xf
  v_add_f32_dpp v62, v62, v62 row_ror:8 row_mask:0xf bank_mask:0xf
  v_add_f32_dpp v63, v63, v63 row_ror:8 row_mask:0xf bank_mask:0xf
  v_add_f32_dpp v48, v48, v48 row_ror:4 row_mask:0xf bank_mask:0xf
  v_add_f32_dpp v49, v49, v49 row_ror:4 row_mask:0xf bank_mask:0xf
  v_add_f32_dpp v50, v50, v50 row_ror:4 row_mask:0xf bank_mask:0xf
  v_add_f32_dpp v51, v51, v51 row_ror:4 row_mask:0xf bank_mask:0xf
  v_add_f32_dpp v52, v52, v52 row_ror:4 row_mask:0xf bank_mask:0xf
  v_add_f32_dpp v53, v53, v53 row_ror:4 row_mask:0xf bank_mask:0xf
  v_add_f32_dpp v54, v54, v54 row_ror:4 row_mask:0xf bank_mask:0xf
  v_add_f32_dpp v55, v55, v55 row_ror:4 row_mask:0xf bank_mask:0xf
  v_add_f32_dpp v56, v56, v56 row_ror:4 row_mask:0xf bank_mask:0xf
  v_add_f32_dpp v57, v57, v57 row_ror:4 row_mask:0xf bank_mask:0xf
  v_add_f32_dpp v58, v58, v58 row_ror:4 row_mask:0xf bank_mask:0xf
  v_add_f32_dpp v59, v59, v59 row_ror:4 row_mask:0xf bank_mask:0xf
  v_add_f32_dpp v60, v60, v60 row_ror:4 row_mask:0xf bank_mask:0xf
  v_add_f32_dpp v61, v61, v61 row_ror:4 row_mask:0xf bank_mask:0xf
  v_add_f32_dpp v62, v62, v62 row_ror:4 row_mask:0xf bank_mask:0xf
  v_add_f32_dpp v63, v63, v63 row_ror:4 row_mask:0xf bank_mask:0xf
  v_add_f32_dpp v48, v48, v48 row_ror:2 row_mask:0xf bank_mask:0xf
  v_add_f32_dpp v49, v49, v49 row_ror:2 row_mask:0xf bank_mask:0xf
  v_add_f32_dpp v50, v50, v50 row_ror:2 row_mask:0xf bank_mask:0xf
  v_add_f32_dpp v51, v51, v51 row_ror:2 row_mask:0xf bank_mask:0xf
  v_add_f32_dpp v52, v52, v52 row_ror:2 row_mask:0xf bank_mask:0xf
  v_add_f32_dpp v53, v53, v53 row_ror:2 row_mask:0xf bank_mask:0xf
  v_add_f32_dpp v54, v54, v54 row_ror:2 row_mask:0xf bank_mask:0xf
  v_add_f32_dpp v55, v55, v55 row_ror:2 row_mask:0xf bank_mask:0xf
  v_add_f32_dpp v56, v56, v56 row_ror:2 row_mask:0xf bank_mask:0xf
  v_add_f32_dpp v57, v57, v57 row_ror:2 row_mask:0xf bank_mask:0xf
  v_add_f32_dpp v58, v58, v58 row_ror:2 row_mask:0xf bank_mask:0xf
  v_add_f32_dpp v59, v59, v59 row_ror:2 row_mask:0xf bank_mask:0xf
  v_add_f32_dpp v60, v60, v60 row_ror:2 row_mask:0xf bank_mask:0xf
  v_add_f32_dpp v61, v61, v61 row_ror:2 row_mask:0xf bank_mask:0xf
  v_add_f32_dpp v62, v62, v62 row_ror:2 row_mask:0xf bank_mask:0xf
  v_add_f32_dpp v63, v63, v63 row_ror:2 row_mask:0xf bank_mask:0xf
  v_add_f32_dpp v48, v48, v48 row_ror:1 row_mask:0xf bank_mask:0xf
  v_add_f32_dpp v49, v49, v49 row_ror:1 row_mask:0xf bank_mask:0xf
  v_add_f32_dpp v50, v50, v50 row_ror:1 row_mask:0xf bank_mask:0xf
  v_add_f32_dpp v51, v51, v51 row_ror:1 row_mask:0xf bank_mask:0xf
  v_add_f32_dpp v52, v52, v52 row_ror:1 row_mask:0xf bank_mask:0xf
  v_add_f32_dpp v53, v53, v53 row_ror:1 row_mask:0xf bank_mask:0xf
  v_add_f32_dpp v54, v54, v54 row_ror:1 row_mask:0xf bank_mask:0xf
  v_add_f32_dpp v55, v55, v55 row_ror:1 row_mask:0xf bank_mask:0xf
  v_add_f32_dpp v56, v56, v56 row_ror:1 row_mask:0xf bank_mask:0xf
  v_add_f32_dpp v57, v57, v57 row_ror:1 row_mask:0xf bank_mask:0xf
  v_add_f32_dpp v58, v58, v58 row_ror:1 row_mask:0xf bank_mask:0xf
  v_add_f32_dpp v59, v59, v59 row_ror:1 row_mask:0xf bank_mask:0xf
  v_add_f32_dpp v60, v60, v60 row_ror:1 row_mask:0xf bank_mask:0xf
  v_add_f32_dpp v61, v61, v61 row_ror:1 row_mask:0xf bank_mask:0xf
  v_add_f32_dpp v62, v62, v62 row_ror:1 row_mask:0xf bank_mask:0xf
  v_add_f32_dpp v63, v63, v63 row_ror:1 row_mask:0xf bank_mask:0xf
  v_cvt_pk_bf16_f32 v80, v48, v49
  v_cvt_pk_bf16_f32 v81, v50, v51
  v_cvt_pk_bf16_f32 v82, v52, v53
  v_cvt_pk_bf16_f32 v83, v54, v55
  v_cvt_pk_bf16_f32 v84, v56, v57
  v_cvt_pk_bf16_f32 v85, v58, v59
  v_cvt_pk_bf16_f32 v86, v60, v61
  v_cvt_pk_bf16_f32 v87, v62, v63
  s_mov_b32 exec_lo, 0x00010001
  s_mov_b32 exec_hi, 0x00010001
  buffer_store_dwordx4 v[80:83], v31, s[16:19], s72 offen offset:32 sc1
  buffer_store_dwordx4 v[84:87], v31, s[16:19], s73 offen offset:32 sc1
  s_mov_b64 exec, -1
  v_dot2_f32_bf16 v48, v224, v32, 0
  v_dot2_f32_bf16 v49, v228, v32, 0
  v_dot2_f32_bf16 v50, v232, v32, 0
  v_dot2_f32_bf16 v51, v236, v32, 0
  v_dot2_f32_bf16 v52, v240, v32, 0
  v_dot2_f32_bf16 v53, v244, v32, 0
  v_dot2_f32_bf16 v54, v248, v32, 0
  v_dot2_f32_bf16 v55, v252, v32, 0
  v_dot2_f32_bf16 v48, v225, v33, v48
  v_dot2_f32_bf16 v49, v229, v33, v49
  v_dot2_f32_bf16 v50, v233, v33, v50
  v_dot2_f32_bf16 v51, v237, v33, v51
  v_dot2_f32_bf16 v52, v241, v33, v52
  v_dot2_f32_bf16 v53, v245, v33, v53
  v_dot2_f32_bf16 v54, v249, v33, v54
  v_dot2_f32_bf16 v55, v253, v33, v55
  v_dot2_f32_bf16 v48, v226, v34, v48
  v_dot2_f32_bf16 v49, v230, v34, v49
  v_dot2_f32_bf16 v50, v234, v34, v50
  v_dot2_f32_bf16 v51, v238, v34, v51
  v_dot2_f32_bf16 v52, v242, v34, v52
  v_dot2_f32_bf16 v53, v246, v34, v53
  v_dot2_f32_bf16 v54, v250, v34, v54
  v_dot2_f32_bf16 v55, v254, v34, v55
  v_dot2_f32_bf16 v48, v227, v35, v48
  v_dot2_f32_bf16 v49, v231, v35, v49
  v_dot2_f32_bf16 v50, v235, v35, v50
  v_dot2_f32_bf16 v51, v239, v35, v51
  v_dot2_f32_bf16 v52, v243, v35, v52
  v_dot2_f32_bf16 v53, v247, v35, v53
  v_dot2_f32_bf16 v54, v251, v35, v54
  v_dot2_f32_bf16 v55, v255, v35, v55
  v_dot2_f32_bf16 v56, v224, v36, 0
  v_dot2_f32_bf16 v57, v228, v36, 0
  v_dot2_f32_bf16 v58, v232, v36, 0
  v_dot2_f32_bf16 v59, v236, v36, 0
  v_dot2_f32_bf16 v60, v240, v36, 0
  v_dot2_f32_bf16 v61, v244, v36, 0
  v_dot2_f32_bf16 v62, v248, v36, 0
  v_dot2_f32_bf16 v63, v252, v36, 0
  v_dot2_f32_bf16 v56, v225, v37, v56
  v_dot2_f32_bf16 v57, v229, v37, v57
  v_dot2_f32_bf16 v58, v233, v37, v58
  v_dot2_f32_bf16 v59, v237, v37, v59
  v_dot2_f32_bf16 v60, v241, v37, v60
  v_dot2_f32_bf16 v61, v245, v37, v61
  v_dot2_f32_bf16 v62, v249, v37, v62
  v_dot2_f32_bf16 v63, v253, v37, v63
  v_dot2_f32_bf16 v56, v226, v38, v56
  v_dot2_f32_bf16 v57, v230, v38, v57
  v_dot2_f32_bf16 v58, v234, v38, v58
  v_dot2_f32_bf16 v59, v238, v38, v59
  v_dot2_f32_bf16 v60, v242, v38, v60
  v_dot2_f32_bf16 v61, v246, v38, v61
  v_dot2_f32_bf16 v62, v250, v38, v62
  v_dot2_f32_bf16 v63, v254, v38, v63
  v_dot2_f32_bf16 v56, v227, v39, v56
  v_dot2_f32_bf16 v57, v231, v39, v57
  v_dot2_f32_bf16 v58, v235, v39, v58
  v_dot2_f32_bf16 v59, v239, v39, v59
  v_dot2_f32_bf16 v60, v243, v39, v60
  v_dot2_f32_bf16 v61, v247, v39, v61
  v_dot2_f32_bf16 v62, v251, v39, v62
  v_dot2_f32_bf16 v63, v255, v39, v63
  v_add_f32_dpp v48, v48, v48 row_ror:8 row_mask:0xf bank_mask:0xf
  v_add_f32_dpp v49, v49, v49 row_ror:8 row_mask:0xf bank_mask:0xf
  v_add_f32_dpp v50, v50, v50 row_ror:8 row_mask:0xf bank_mask:0xf
  v_add_f32_dpp v51, v51, v51 row_ror:8 row_mask:0xf bank_mask:0xf
  v_add_f32_dpp v52, v52, v52 row_ror:8 row_mask:0xf bank_mask:0xf
  v_add_f32_dpp v53, v53, v53 row_ror:8 row_mask:0xf bank_mask:0xf
  v_add_f32_dpp v54, v54, v54 row_ror:8 row_mask:0xf bank_mask:0xf
  v_add_f32_dpp v55, v55, v55 row_ror:8 row_mask:0xf bank_mask:0xf
  v_add_f32_dpp v56, v56, v56 row_ror:8 row_mask:0xf bank_mask:0xf
  v_add_f32_dpp v57, v57, v57 row_ror:8 row_mask:0xf bank_mask:0xf
  v_add_f32_dpp v58, v58, v58 row_ror:8 row_mask:0xf bank_mask:0xf
  v_add_f32_dpp v59, v59, v59 row_ror:8 row_mask:0xf bank_mask:0xf
  v_add_f32_dpp v60, v60, v60 row_ror:8 row_mask:0xf bank_mask:0xf
  v_add_f32_dpp v61, v61, v61 row_ror:8 row_mask:0xf bank_mask:0xf
  v_add_f32_dpp v62, v62, v62 row_ror:8 row_mask:0xf bank_mask:0xf
  v_add_f32_dpp v63, v63, v63 row_ror:8 row_mask:0xf bank_mask:0xf
  v_add_f32_dpp v48, v48, v48 row_ror:4 row_mask:0xf bank_mask:0xf
  v_add_f32_dpp v49, v49, v49 row_ror:4 row_mask:0xf bank_mask:0xf
  v_add_f32_dpp v50, v50, v50 row_ror:4 row_mask:0xf bank_mask:0xf
  v_add_f32_dpp v51, v51, v51 row_ror:4 row_mask:0xf bank_mask:0xf
  v_add_f32_dpp v52, v52, v52 row_ror:4 row_mask:0xf bank_mask:0xf
  v_add_f32_dpp v53, v53, v53 row_ror:4 row_mask:0xf bank_mask:0xf
  v_add_f32_dpp v54, v54, v54 row_ror:4 row_mask:0xf bank_mask:0xf
  v_add_f32_dpp v55, v55, v55 row_ror:4 row_mask:0xf bank_mask:0xf
  v_add_f32_dpp v56, v56, v56 row_ror:4 row_mask:0xf bank_mask:0xf
  v_add_f32_dpp v57, v57, v57 row_ror:4 row_mask:0xf bank_mask:0xf
  v_add_f32_dpp v58, v58, v58 row_ror:4 row_mask:0xf bank_mask:0xf
  v_add_f32_dpp v59, v59, v59 row_ror:4 row_mask:0xf bank_mask:0xf
  v_add_f32_dpp v60, v60, v60 row_ror:4 row_mask:0xf bank_mask:0xf
  v_add_f32_dpp v61, v61, v61 row_ror:4 row_mask:0xf bank_mask:0xf
  v_add_f32_dpp v62, v62, v62 row_ror:4 row_mask:0xf bank_mask:0xf
  v_add_f32_dpp v63, v63, v63 row_ror:4 row_mask:0xf bank_mask:0xf
  v_add_f32_dpp v48, v48, v48 row_ror:2 row_mask:0xf bank_mask:0xf
  v_add_f32_dpp v49, v49, v49 row_ror:2 row_mask:0xf bank_mask:0xf
  v_add_f32_dpp v50, v50, v50 row_ror:2 row_mask:0xf bank_mask:0xf
  v_add_f32_dpp v51, v51, v51 row_ror:2 row_mask:0xf bank_mask:0xf
  v_add_f32_dpp v52, v52, v52 row_ror:2 row_mask:0xf bank_mask:0xf
  v_add_f32_dpp v53, v53, v53 row_ror:2 row_mask:0xf bank_mask:0xf
  v_add_f32_dpp v54, v54, v54 row_ror:2 row_mask:0xf bank_mask:0xf
  v_add_f32_dpp v55, v55, v55 row_ror:2 row_mask:0xf bank_mask:0xf
  v_add_f32_dpp v56, v56, v56 row_ror:2 row_mask:0xf bank_mask:0xf
  v_add_f32_dpp v57, v57, v57 row_ror:2 row_mask:0xf bank_mask:0xf
  v_add_f32_dpp v58, v58, v58 row_ror:2 row_mask:0xf bank_mask:0xf
  v_add_f32_dpp v59, v59, v59 row_ror:2 row_mask:0xf bank_mask:0xf
  v_add_f32_dpp v60, v60, v60 row_ror:2 row_mask:0xf bank_mask:0xf
  v_add_f32_dpp v61, v61, v61 row_ror:2 row_mask:0xf bank_mask:0xf
  v_add_f32_dpp v62, v62, v62 row_ror:2 row_mask:0xf bank_mask:0xf
  v_add_f32_dpp v63, v63, v63 row_ror:2 row_mask:0xf bank_mask:0xf
  v_add_f32_dpp v48, v48, v48 row_ror:1 row_mask:0xf bank_mask:0xf
  v_add_f32_dpp v49, v49, v49 row_ror:1 row_mask:0xf bank_mask:0xf
  v_add_f32_dpp v50, v50, v50 row_ror:1 row_mask:0xf bank_mask:0xf
  v_add_f32_dpp v51, v51, v51 row_ror:1 row_mask:0xf bank_mask:0xf
  v_add_f32_dpp v52, v52, v52 row_ror:1 row_mask:0xf bank_mask:0xf
  v_add_f32_dpp v53, v53, v53 row_ror:1 row_mask:0xf bank_mask:0xf
  v_add_f32_dpp v54, v54, v54 row_ror:1 row_mask:0xf bank_mask:0xf
  v_add_f32_dpp v55, v55, v55 row_ror:1 row_mask:0xf bank_mask:0xf
  v_add_f32_dpp v56, v56, v56 row_ror:1 row_mask:0xf bank_mask:0xf
  v_add_f32_dpp v57, v57, v57 row_ror:1 row_mask:0xf bank_mask:0xf
  v_add_f32_dpp v58, v58, v58 row_ror:1 row_mask:0xf bank_mask:0xf
  v_add_f32_dpp v59, v59, v59 row_ror:1 row_mask:0xf bank_mask:0xf
  v_add_f32_dpp v60, v60, v60 row_ror:1 row_mask:0xf bank_mask:0xf
  v_add_f32_dpp v61, v61, v61 row_ror:1 row_mask:0xf bank_mask:0xf
  v_add_f32_dpp v62, v62, v62 row_ror:1 row_mask:0xf bank_mask:0xf
  v_add_f32_dpp v63, v63, v63 row_ror:1 row_mask:0xf bank_mask:0xf
  v_cvt_pk_bf16_f32 v88, v48, v49
  v_cvt_pk_bf16_f32 v89, v50, v51
  v_cvt_pk_bf16_f32 v90, v52, v53
  v_cvt_pk_bf16_f32 v91, v54, v55
  v_cvt_pk_bf16_f32 v92, v56, v57
  v_cvt_pk_bf16_f32 v93, v58, v59
  v_cvt_pk_bf16_f32 v94, v60, v61
  v_cvt_pk_bf16_f32 v95, v62, v63
  s_mov_b32 exec_lo, 0x00010001
  s_mov_b32 exec_hi, 0x00010001
  buffer_store_dwordx4 v[88:91], v31, s[16:19], s72 offen offset:48 sc1
  buffer_store_dwordx4 v[92:95], v31, s[16:19], s73 offen offset:48 sc1
  s_mov_b64 exec, -1
  s_lshl_b32 s24, s5, 4
  s_lshl_b32 s25, s63, 2
  s_add_u32 s24, s24, s25
  s_add_u32 s24, s24, 1089536
  v_mov_b32 v28, s7
  s_mov_b64 exec, 1
  s_waitcnt vmcnt(0)
  buffer_store_dword v28, off, s[16:19], s24 sc1
  s_mov_b64 exec, -1
  v_mov_b32 v29, 153112
  v_mov_b32 v28, 1
  s_waitcnt lgkmcnt(0)
  s_mov_b64 exec, 1
  ds_add_u32 v29, v28
  s_mov_b64 exec, -1
  s_setprio 3
  v_mov_b32 v29, 153088
  s_mov_b32 s30, 50000
L_lp17:
  ds_read_b32 v28, v29
  s_waitcnt lgkmcnt(0)
  v_readfirstlane_b32 s31, v28
  s_cmp_ge_u32 s31, 8
  s_cbranch_scc1 L_lpd18
  s_sleep 16
  s_sub_u32 s30, s30, 1
  s_cmp_lg_u32 s30, 0
  s_cbranch_scc1 L_lp17
L_lpd18:
L_setb2:
  s_mov_b32 s8, s50
  s_mov_b32 s9, s51
  s_mov_b32 s10, 0x400000
  s_mov_b32 s11, 0x20000
  s_mov_b32 s25, 0
  s_add_u32 s24, s64, s25
  buffer_load_dwordx4 v[128:131], v5, s[8:11], s24 offen nt
  s_add_u32 s25, s25, 8192
  s_and_b32 s25, s25, 0x3ffff
  s_add_u32 s24, s64, s25
  buffer_load_dwordx4 v[132:135], v5, s[8:11], s24 offen nt
  s_add_u32 s25, s25, 8192
  s_and_b32 s25, s25, 0x3ffff
  s_add_u32 s24, s64, s25
  buffer_load_dwordx4 v[136:139], v5, s[8:11], s24 offen nt
  s_add_u32 s25, s25, 8192
  s_and_b32 s25, s25, 0x3ffff
  s_add_u32 s24, s64, s25
  buffer_load_dwordx4 v[140:143], v5, s[8:11], s24 offen nt
  s_add_u32 s25, s25, 8192
  s_and_b32 s25, s25, 0x3ffff
  s_add_u32 s24, s64, s25
  buffer_load_dwordx4 v[144:147], v5, s[8:11], s24 offen nt
  s_add_u32 s25, s25, 8192
  s_and_b32 s25, s25, 0x3ffff
  s_add_u32 s24, s64, s25
  buffer_load_dwordx4 v[148:151], v5, s[8:11], s24 offen nt
  s_add_u32 s25, s25, 8192
  s_and_b32 s25, s25, 0x3ffff
  s_add_u32 s24, s64, s25
  buffer_load_dwordx4 v[152:155], v5, s[8:11], s24 offen nt
  s_add_u32 s25, s25, 8192
  s_and_b32 s25, s25, 0x3ffff
  s_add_u32 s24, s64, s25
  buffer_load_dwordx4 v[156:159], v5, s[8:11], s24 offen nt
  s_add_u32 s25, s25, 8192
  s_and_b32 s25, s25, 0x3ffff
  s_add_u32 s24, s64, s25
  buffer_load_dwordx4 v[160:163], v5, s[8:11], s24 offen nt
  s_add_u32 s25, s25, 8192
  s_and_b32 s25, s25, 0x3ffff
  s_add_u32 s24, s64, s25
  buffer_load_dwordx4 v[164:167], v5, s[8:11], s24 offen nt
  s_add_u32 s25, s25, 8192
  s_and_b32 s25, s25, 0x3ffff
  s_add_u32 s24, s64, s25
  buffer_load_dwordx4 v[168:171], v5, s[8:11], s24 offen nt
  s_add_u32 s25, s25, 8192
  s_and_b32 s25, s25, 0x3ffff
  s_add_u32 s24, s64, s25
  buffer_load_dwordx4 v[172:175], v5, s[8:11], s24 offen nt
  s_add_u32 s25, s25, 8192
  s_and_b32 s25, s25, 0x3ffff
  s_add_u32 s24, s64, s25
  buffer_load_dwordx4 v[176:179], v5, s[8:11], s24 offen nt
  s_add_u32 s25, s25, 8192
  s_and_b32 s25, s25, 0x3ffff
  s_add_u32 s24, s64, s25
  buffer_load_dwordx4 v[180:183], v5, s[8:11], s24 offen nt
  s_add_u32 s25, s25, 8192
  s_and_b32 s25, s25, 0x3ffff
  s_add_u32 s24, s64, s25
  buffer_load_dwordx4 v[184:187], v5, s[8:11], s24 offen nt
  s_add_u32 s25, s25, 8192
  s_and_b32 s25, s25, 0x3ffff
  s_add_u32 s24, s64, s25
  buffer_load_dwordx4 v[188:191], v5, s[8:11], s24 offen nt
  s_add_u32 s25, s25, 8192
  s_and_b32 s25, s25, 0x3ffff
  s_add_u32 s24, s64, s25
  buffer_load_dwordx4 v[192:195], v5, s[8:11], s24 offen nt
  s_add_u32 s25, s25, 8192
  s_and_b32 s25, s25, 0x3ffff
  s_add_u32 s24, s64, s25
  buffer_load_dwordx4 v[196:199], v5, s[8:11], s24 offen nt
  s_add_u32 s25, s25, 8192
  s_and_b32 s25, s25, 0x3ffff
  s_add_u32 s24, s64, s25
  buffer_load_dwordx4 v[200:203], v5, s[8:11], s24 offen nt
  s_add_u32 s25, s25, 8192
  s_and_b32 s25, s25, 0x3ffff
  s_add_u32 s24, s64, s25
  buffer_load_dwordx4 v[204:207], v5, s[8:11], s24 offen nt
  s_add_u32 s25, s25, 8192
  s_and_b32 s25, s25, 0x3ffff
  s_add_u32 s24, s64, s25
  buffer_load_dwordx4 v[208:211], v5, s[8:11], s24 offen nt
  s_add_u32 s25, s25, 8192
  s_and_b32 s25, s25, 0x3ffff
  s_add_u32 s24, s64, s25
  buffer_load_dwordx4 v[212:215], v5, s[8:11], s24 offen nt
  s_add_u32 s25, s25, 8192
  s_and_b32 s25, s25, 0x3ffff
  s_add_u32 s24, s64, s25
  buffer_load_dwordx4 v[216:219], v5, s[8:11], s24 offen nt
  s_add_u32 s25, s25, 8192
  s_and_b32 s25, s25, 0x3ffff
  s_add_u32 s24, s64, s25
  buffer_load_dwordx4 v[220:223], v5, s[8:11], s24 offen nt
  s_add_u32 s25, s25, 8192
  s_and_b32 s25, s25, 0x3ffff
  s_add_u32 s24, s64, s25
  buffer_load_dwordx4 v[224:227], v5, s[8:11], s24 offen nt
  s_add_u32 s25, s25, 8192
  s_and_b32 s25, s25, 0x3ffff
  s_add_u32 s24, s64, s25
  buffer_load_dwordx4 v[228:231], v5, s[8:11], s24 offen nt
  s_add_u32 s25, s25, 8192
  s_and_b32 s25, s25, 0x3ffff
  s_add_u32 s24, s64, s25
  buffer_load_dwordx4 v[232:235], v5, s[8:11], s24 offen nt
  s_add_u32 s25, s25, 8192
  s_and_b32 s25, s25, 0x3ffff
  s_add_u32 s24, s64, s25
  buffer_load_dwordx4 v[236:239], v5, s[8:11], s24 offen nt
  s_add_u32 s25, s25, 8192
  s_and_b32 s25, s25, 0x3ffff
  s_add_u32 s24, s64, s25
  buffer_load_dwordx4 v[240:243], v5, s[8:11], s24 offen nt
  s_add_u32 s25, s25, 8192
  s_and_b32 s25, s25, 0x3ffff
  s_add_u32 s24, s64, s25
  buffer_load_dwordx4 v[244:247], v5, s[8:11], s24 offen nt
  s_add_u32 s25, s25, 8192
  s_and_b32 s25, s25, 0x3ffff
  s_add_u32 s24, s64, s25
  buffer_load_dwordx4 v[248:251], v5, s[8:11], s24 offen nt
  s_add_u32 s25, s25, 8192
  s_and_b32 s25, s25, 0x3ffff
  s_add_u32 s24, s64, s25
  buffer_load_dwordx4 v[252:255], v5, s[8:11], s24 offen nt
  s_lshl_b32 s71, s5, 11
  s_lshr_b32 s24, s63, 1
  s_lshl_b32 s24, s24, 10
  s_add_u32 s71, s71, s24
  s_add_u32 s71, s71, 1179648
  s_mov_b32 s30, 50000
L_gp19:
  buffer_load_dwordx4 v[32:35], v2, s[16:19], s71 offen sc1
  s_waitcnt vmcnt(0)
  v_mov_b32 v28, v33
  v_mov_b32 v29, v33
  v_min3_u32 v28, v28, v35, v35
  v_max3_u32 v29, v29, v35, v35
  v_cmp_eq_u32 s[24:25], s7, v28
  v_cmp_eq_u32 vcc, s7, v29
  s_and_b64 vcc, vcc, s[24:25]
  s_cmp_eq_u64 vcc, -1
  s_cbranch_scc1 L_gpd20
  s_sleep 16
  s_sub_u32 s30, s30, 1
  s_cmp_lg_u32 s30, 0
  s_cbranch_scc1 L_gp19
L_gpd20:
  v_lshlrev_b32 v30, 12, v3
  v_lshl_add_u32 v30, v4, 4, v30
  s_lshl_b32 s24, s5, 2
  s_add_u32 s24, s24, s63
  s_lshl_b32 s24, s24, 14
  s_add_u32 s24, s24, 3145728
  buffer_load_dwordx4 v[48:51], v30, s[16:19], s24 offen offset:0 sc1
  buffer_load_dwordx4 v[52:55], v30, s[16:19], s24 offen offset:256 sc1
  buffer_load_dwordx4 v[56:59], v30, s[16:19], s24 offen offset:512 sc1
  buffer_load_dwordx4 v[60:63], v30, s[16:19], s24 offen offset:768 sc1
  buffer_load_dwordx4 v[64:67], v30, s[16:19], s24 offen offset:1024 sc1
  buffer_load_dwordx4 v[68:71], v30, s[16:19], s24 offen offset:1280 sc1
  buffer_load_dwordx4 v[72:75], v30, s[16:19], s24 offen offset:1536 sc1
  buffer_load_dwordx4 v[76:79], v30, s[16:19], s24 offen offset:1792 sc1
  buffer_load_dwordx4 v[80:83], v30, s[16:19], s24 offen offset:2048 sc1
  buffer_load_dwordx4 v[84:87], v30, s[16:19], s24 offen offset:2304 sc1
  buffer_load_dwordx4 v[88:91], v30, s[16:19], s24 offen offset:2560 sc1
  buffer_load_dwordx4 v[92:95], v30, s[16:19], s24 offen offset:2816 sc1
  buffer_load_dwordx4 v[96:99], v30, s[16:19], s24 offen offset:3072 sc1
  buffer_load_dwordx4 v[100:103], v30, s[16:19], s24 offen offset:3328 sc1
  buffer_load_dwordx4 v[104:107], v30, s[16:19], s24 offen offset:3584 sc1
  buffer_load_dwordx4 v[108:111], v30, s[16:19], s24 offen offset:3840 sc1
  v_mov_b32 v36, v32
  s_nop 1
  v_max_f32_dpp v36, v36, v36 row_ror:8 row_mask:0xf bank_mask:0xf
  s_nop 1
  v_max_f32_dpp v36, v36, v36 row_ror:4 row_mask:0xf bank_mask:0xf
  s_nop 1
  v_max_f32_dpp v36, v36, v36 row_ror:2 row_mask:0xf bank_mask:0xf
  s_nop 1
  v_max_f32_dpp v36, v36, v36 row_ror:1 row_mask:0xf bank_mask:0xf
  v_mov_b32 v37, v36
  s_nop 1
  v_permlane16_swap_b32 v36, v37
  v_max_f32 v36, v36, v37
  v_sub_f32 v32, v32, v36
  v_mul_f32 v32, 0x3fb8aa3b, v32
  v_exp_f32 v32, v32
  s_nop 0
  v_mul_f32 v36, v32, v34
  s_nop 1
  v_add_f32_dpp v36, v36, v36 row_ror:8 row_mask:0xf bank_mask:0xf
  s_nop 1
  v_add_f32_dpp v36, v36, v36 row_ror:4 row_mask:0xf bank_mask:0xf
  s_nop 1
  v_add_f32_dpp v36, v36, v36 row_ror:2 row_mask:0xf bank_mask:0xf
  s_nop 1
  v_add_f32_dpp v36, v36, v36 row_ror:1 row_mask:0xf bank_mask:0xf
  v_mov_b32 v37, v36
  s_nop 1
  v_permlane16_swap_b32 v36, v37
  v_add_f32 v36, v36, v37
  v_rcp_f32 v36, v36
  s_nop 0
  v_mul_f32 v32, v32, v36
  v_cvt_pk_bf16_f32 v32, v32, v32
  s_lshl_b32 s24, s3, 9
  s_add_u32 s74, s24, 143360
  v_lshlrev_b32 v30, 1, v0
  v_add_u32 v30, s74, v30
  ds_write_b16 v30, v32
  v_lshlrev_b32 v30, 5, v3
  v_add_u32 v30, s74, v30
  s_waitcnt lgkmcnt(0)
  ds_read_b128 v[112:115], v30 offset:0
  ds_read_b128 v[116:119], v30 offset:16
  v_lshrrev_b32 v30, 3, v4
  v_lshrrev_b32 v31, 1, v3
  v_cmp_eq_u32 vcc, v30, v31
  s_waitcnt lgkmcnt(0)
  s_nop 0
  v_cndmask_b32 v112, 0, v112, vcc
  v_cndmask_b32 v113, 0, v113, vcc
  v_cndmask_b32 v114, 0, v114, vcc
  v_cndmask_b32 v115, 0, v115, vcc
  v_cndmask_b32 v116, 0, v116, vcc
  v_cndmask_b32 v117, 0, v117, vcc
  v_cndmask_b32 v118, 0, v118, vcc
  v_cndmask_b32 v119, 0, v119, vcc
  s_waitcnt vmcnt(12)
  v_perm_b32 v16, v112, v112, v8
  v_perm_b32 v17, v112, v112, v9
  v_perm_b32 v18, v112, v112, v10
  v_perm_b32 v19, v112, v112, v11
  s_nop 1
  v_mfma_f32_16x16x32_bf16 v[24:27], v[48:51], v[16:19], 0
  v_perm_b32 v20, v112, v112, v12
  v_perm_b32 v21, v112, v112, v13
  v_perm_b32 v22, v112, v112, v14
  v_perm_b32 v23, v112, v112, v15
  s_nop 1
  v_mfma_f32_16x16x32_bf16 v[24:27], v[52:55], v[20:23], v[24:27]
  v_perm_b32 v16, v113, v113, v8
  v_perm_b32 v17, v113, v113, v9
  v_perm_b32 v18, v113, v113, v10
  v_perm_b32 v19, v113, v113, v11
  s_nop 1
  v_mfma_f32_16x16x32_bf16 v[24:27], v[56:59], v[16:19], v[24:27]
  v_perm_b32 v20, v113, v113, v12
  v_perm_b32 v21, v113, v113, v13
  v_perm_b32 v22, v113, v113, v14
  v_perm_b32 v23, v113, v113, v15
  s_nop 1
  v_mfma_f32_16x16x32_bf16 v[24:27], v[60:63], v[20:23], v[24:27]
  s_waitcnt vmcnt(8)
  v_perm_b32 v16, v114, v114, v8
  v_perm_b32 v17, v114, v114, v9
  v_perm_b32 v18, v114, v114, v10
  v_perm_b32 v19, v114, v114, v11
  s_nop 1
  v_mfma_f32_16x16x32_bf16 v[24:27], v[64:67], v[16:19], v[24:27]
  v_perm_b32 v20, v114, v114, v12
  v_perm_b32 v21, v114, v114, v13
  v_perm_b32 v22, v114, v114, v14
  v_perm_b32 v23, v114, v114, v15
  s_nop 1
  v_mfma_f32_16x16x32_bf16 v[24:27], v[68:71], v[20:23], v[24:27]
  v_perm_b32 v16, v115, v115, v8
  v_perm_b32 v17, v115, v115, v9
  v_perm_b32 v18, v115, v115, v10
  v_perm_b32 v19, v115, v115, v11
  s_nop 1
  v_mfma_f32_16x16x32_bf16 v[24:27], v[72:75], v[16:19], v[24:27]
  v_perm_b32 v20, v115, v115, v12
  v_perm_b32 v21, v115, v115, v13
  v_perm_b32 v22, v115, v115, v14
  v_perm_b32 v23, v115, v115, v15
  s_nop 1
  v_mfma_f32_16x16x32_bf16 v[24:27], v[76:79], v[20:23], v[24:27]
  s_waitcnt vmcnt(4)
  v_perm_b32 v16, v116, v116, v8
  v_perm_b32 v17, v116, v116, v9
  v_perm_b32 v18, v116, v116, v10
  v_perm_b32 v19, v116, v116, v11
  s_nop 1
  v_mfma_f32_16x16x32_bf16 v[24:27], v[80:83], v[16:19], v[24:27]
  v_perm_b32 v20, v116, v116, v12
  v_perm_b32 v21, v116, v116, v13
  v_perm_b32 v22, v116, v116, v14
  v_perm_b32 v23, v116, v116, v15
  s_nop 1
  v_mfma_f32_16x16x32_bf16 v[24:27], v[84:87], v[20:23], v[24:27]
  v_perm_b32 v16, v117, v117, v8
  v_perm_b32 v17, v117, v117, v9
  v_perm_b32 v18, v117, v117, v10
  v_perm_b32 v19, v117, v117, v11
  s_nop 1
  v_mfma_f32_16x16x32_bf16 v[24:27], v[88:91], v[16:19], v[24:27]
  v_perm_b32 v20, v117, v117, v12
  v_perm_b32 v21, v117, v117, v13
  v_perm_b32 v22, v117, v117, v14
  v_perm_b32 v23, v117, v117, v15
  s_nop 1
  v_mfma_f32_16x16x32_bf16 v[24:27], v[92:95], v[20:23], v[24:27]
  s_waitcnt vmcnt(0)
  v_perm_b32 v16, v118, v118, v8
  v_perm_b32 v17, v118, v118, v9
  v_perm_b32 v18, v118, v118, v10
  v_perm_b32 v19, v118, v118, v11
  s_nop 1
  v_mfma_f32_16x16x32_bf16 v[24:27], v[96:99], v[16:19], v[24:27]
  v_perm_b32 v20, v118, v118, v12
  v_perm_b32 v21, v118, v118, v13
  v_perm_b32 v22, v118, v118, v14
  v_perm_b32 v23, v118, v118, v15
  s_nop 1
  v_mfma_f32_16x16x32_bf16 v[24:27], v[100:103], v[20:23], v[24:27]
  v_perm_b32 v16, v119, v119, v8
  v_perm_b32 v17, v119, v119, v9
  v_perm_b32 v18, v119, v119, v10
  v_perm_b32 v19, v119, v119, v11
  s_nop 1
  v_mfma_f32_16x16x32_bf16 v[24:27], v[104:107], v[16:19], v[24:27]
  v_perm_b32 v20, v119, v119, v12
  v_perm_b32 v21, v119, v119, v13
  v_perm_b32 v22, v119, v119, v14
  v_perm_b32 v23, v119, v119, v15
  s_nop 1
  v_mfma_f32_16x16x32_bf16 v[24:27], v[108:111], v[20:23], v[24:27]
  s_nop 7
  v_cvt_pk_bf16_f32 v28, v24, v25
  v_cvt_pk_bf16_f32 v29, v26, v27
  v_add_u32 v30, s74, v7
  v_lshl_add_u32 v31, v1, 1, v30
  ds_write_b16 v31, v28
  ds_write_b16_d16_hi v31, v28 offset:16
  ds_write_b16 v31, v29 offset:32
  ds_write_b16_d16_hi v31, v29 offset:48
  s_waitcnt lgkmcnt(0)
  ds_read_b128 v[112:115], v30 offset:0
  ds_read_b128 v[116:119], v30 offset:16
  ds_read_b128 v[120:123], v30 offset:32
  ds_read_b128 v[124:127], v30 offset:48
  s_waitcnt lgkmcnt(0)
  v_perm_b32 v16, v112, v112, v8
  v_perm_b32 v17, v112, v112, v9
  v_perm_b32 v18, v112, v112, v10
  v_perm_b32 v19, v112, v112, v11
  s_nop 1
  v_mfma_f32_16x16x32_bf16 v[24:27], v[128:131], v[16:19], 0
  v_perm_b32 v20, v112, v112, v12
  v_perm_b32 v21, v112, v112, v13
  v_perm_b32 v22, v112, v112, v14
  v_perm_b32 v23, v112, v112, v15
  s_nop 1
  v_mfma_f32_16x16x32_bf16 v[24:27], v[132:135], v[20:23], v[24:27]
  v_perm_b32 v16, v113, v113, v8
  v_perm_b32 v17, v113, v113, v9
  v_perm_b32 v18, v113, v113, v10
  v_perm_b32 v19, v113, v113, v11
  s_nop 1
  v_mfma_f32_16x16x32_bf16 v[24:27], v[136:139], v[16:19], v[24:27]
  v_perm_b32 v20, v113, v113, v12
  v_perm_b32 v21, v113, v113, v13
  v_perm_b32 v22, v113, v113, v14
  v_perm_b32 v23, v113, v113, v15
  s_nop 1
  v_mfma_f32_16x16x32_bf16 v[24:27], v[140:143], v[20:23], v[24:27]
  v_perm_b32 v16, v114, v114, v8
  v_perm_b32 v17, v114, v114, v9
  v_perm_b32 v18, v114, v114, v10
  v_perm_b32 v19, v114, v114, v11
  s_nop 1
  v_mfma_f32_16x16x32_bf16 v[24:27], v[144:147], v[16:19], v[24:27]
  v_perm_b32 v20, v114, v114, v12
  v_perm_b32 v21, v114, v114, v13
  v_perm_b32 v22, v114, v114, v14
  v_perm_b32 v23, v114, v114, v15
  s_nop 1
  v_mfma_f32_16x16x32_bf16 v[24:27], v[148:151], v[20:23], v[24:27]
  v_perm_b32 v16, v115, v115, v8
  v_perm_b32 v17, v115, v115, v9
  v_perm_b32 v18, v115, v115, v10
  v_perm_b32 v19, v115, v115, v11
  s_nop 1
  v_mfma_f32_16x16x32_bf16 v[24:27], v[152:155], v[16:19], v[24:27]
  v_perm_b32 v20, v115, v115, v12
  v_perm_b32 v21, v115, v115, v13
  v_perm_b32 v22, v115, v115, v14
  v_perm_b32 v23, v115, v115, v15
  s_nop 1
  v_mfma_f32_16x16x32_bf16 v[24:27], v[156:159], v[20:23], v[24:27]
  v_perm_b32 v16, v116, v116, v8
  v_perm_b32 v17, v116, v116, v9
  v_perm_b32 v18, v116, v116, v10
  v_perm_b32 v19, v116, v116, v11
  s_nop 1
  v_mfma_f32_16x16x32_bf16 v[24:27], v[160:163], v[16:19], v[24:27]
  v_perm_b32 v20, v116, v116, v12
  v_perm_b32 v21, v116, v116, v13
  v_perm_b32 v22, v116, v116, v14
  v_perm_b32 v23, v116, v116, v15
  s_nop 1
  v_mfma_f32_16x16x32_bf16 v[24:27], v[164:167], v[20:23], v[24:27]
  v_perm_b32 v16, v117, v117, v8
  v_perm_b32 v17, v117, v117, v9
  v_perm_b32 v18, v117, v117, v10
  v_perm_b32 v19, v117, v117, v11
  s_nop 1
  v_mfma_f32_16x16x32_bf16 v[24:27], v[168:171], v[16:19], v[24:27]
  v_perm_b32 v20, v117, v117, v12
  v_perm_b32 v21, v117, v117, v13
  v_perm_b32 v22, v117, v117, v14
  v_perm_b32 v23, v117, v117, v15
  s_nop 1
  v_mfma_f32_16x16x32_bf16 v[24:27], v[172:175], v[20:23], v[24:27]
  v_perm_b32 v16, v118, v118, v8
  v_perm_b32 v17, v118, v118, v9
  v_perm_b32 v18, v118, v118, v10
  v_perm_b32 v19, v118, v118, v11
  s_nop 1
  v_mfma_f32_16x16x32_bf16 v[24:27], v[176:179], v[16:19], v[24:27]
  v_perm_b32 v20, v118, v118, v12
  v_perm_b32 v21, v118, v118, v13
  v_perm_b32 v22, v118, v118, v14
  v_perm_b32 v23, v118, v118, v15
  s_nop 1
  v_mfma_f32_16x16x32_bf16 v[24:27], v[180:183], v[20:23], v[24:27]
  v_perm_b32 v16, v119, v119, v8
  v_perm_b32 v17, v119, v119, v9
  v_perm_b32 v18, v119, v119, v10
  v_perm_b32 v19, v119, v119, v11
  s_nop 1
  v_mfma_f32_16x16x32_bf16 v[24:27], v[184:187], v[16:19], v[24:27]
  v_perm_b32 v20, v119, v119, v12
  v_perm_b32 v21, v119, v119, v13
  v_perm_b32 v22, v119, v119, v14
  v_perm_b32 v23, v119, v119, v15
  s_nop 1
  v_mfma_f32_16x16x32_bf16 v[24:27], v[188:191], v[20:23], v[24:27]
  v_perm_b32 v16, v120, v120, v8
  v_perm_b32 v17, v120, v120, v9
  v_perm_b32 v18, v120, v120, v10
  v_perm_b32 v19, v120, v120, v11
  s_nop 1
  v_mfma_f32_16x16x32_bf16 v[24:27], v[192:195], v[16:19], v[24:27]
  v_perm_b32 v20, v120, v120, v12
  v_perm_b32 v21, v120, v120, v13
  v_perm_b32 v22, v120, v120, v14
  v_perm_b32 v23, v120, v120, v15
  s_nop 1
  v_mfma_f32_16x16x32_bf16 v[24:27], v[196:199], v[20:23], v[24:27]
  v_perm_b32 v16, v121, v121, v8
  v_perm_b32 v17, v121, v121, v9
  v_perm_b32 v18, v121, v121, v10
  v_perm_b32 v19, v121, v121, v11
  s_nop 1
  v_mfma_f32_16x16x32_bf16 v[24:27], v[200:203], v[16:19], v[24:27]
  v_perm_b32 v20, v121, v121, v12
  v_perm_b32 v21, v121, v121, v13
  v_perm_b32 v22, v121, v121, v14
  v_perm_b32 v23, v121, v121, v15
  s_nop 1
  v_mfma_f32_16x16x32_bf16 v[24:27], v[204:207], v[20:23], v[24:27]
  v_perm_b32 v16, v122, v122, v8
  v_perm_b32 v17, v122, v122, v9
  v_perm_b32 v18, v122, v122, v10
  v_perm_b32 v19, v122, v122, v11
  s_nop 1
  v_mfma_f32_16x16x32_bf16 v[24:27], v[208:211], v[16:19], v[24:27]
  v_perm_b32 v20, v122, v122, v12
  v_perm_b32 v21, v122, v122, v13
  v_perm_b32 v22, v122, v122, v14
  v_perm_b32 v23, v122, v122, v15
  s_nop 1
  v_mfma_f32_16x16x32_bf16 v[24:27], v[212:215], v[20:23], v[24:27]
  v_perm_b32 v16, v123, v123, v8
  v_perm_b32 v17, v123, v123, v9
  v_perm_b32 v18, v123, v123, v10
  v_perm_b32 v19, v123, v123, v11
  s_nop 1
  v_mfma_f32_16x16x32_bf16 v[24:27], v[216:219], v[16:19], v[24:27]
  v_perm_b32 v20, v123, v123, v12
  v_perm_b32 v21, v123, v123, v13
  v_perm_b32 v22, v123, v123, v14
  v_perm_b32 v23, v123, v123, v15
  s_nop 1
  v_mfma_f32_16x16x32_bf16 v[24:27], v[220:223], v[20:23], v[24:27]
  v_perm_b32 v16, v124, v124, v8
  v_perm_b32 v17, v124, v124, v9
  v_perm_b32 v18, v124, v124, v10
  v_perm_b32 v19, v124, v124, v11
  s_nop 1
  v_mfma_f32_16x16x32_bf16 v[24:27], v[224:227], v[16:19], v[24:27]
  v_perm_b32 v20, v124, v124, v12
  v_perm_b32 v21, v124, v124, v13
  v_perm_b32 v22, v124, v124, v14
  v_perm_b32 v23, v124, v124, v15
  s_nop 1
  v_mfma_f32_16x16x32_bf16 v[24:27], v[228:231], v[20:23], v[24:27]
  v_perm_b32 v16, v125, v125, v8
  v_perm_b32 v17, v125, v125, v9
  v_perm_b32 v18, v125, v125, v10
  v_perm_b32 v19, v125, v125, v11
  s_nop 1
  v_mfma_f32_16x16x32_bf16 v[24:27], v[232:235], v[16:19], v[24:27]
  v_perm_b32 v20, v125, v125, v12
  v_perm_b32 v21, v125, v125, v13
  v_perm_b32 v22, v125, v125, v14
  v_perm_b32 v23, v125, v125, v15
  s_nop 1
  v_mfma_f32_16x16x32_bf16 v[24:27], v[236:239], v[20:23], v[24:27]
  v_perm_b32 v16, v126, v126, v8
  v_perm_b32 v17, v126, v126, v9
  v_perm_b32 v18, v126, v126, v10
  v_perm_b32 v19, v126, v126, v11
  s_nop 1
  v_mfma_f32_16x16x32_bf16 v[24:27], v[240:243], v[16:19], v[24:27]
  v_perm_b32 v20, v126, v126, v12
  v_perm_b32 v21, v126, v126, v13
  v_perm_b32 v22, v126, v126, v14
  v_perm_b32 v23, v126, v126, v15
  s_nop 1
  v_mfma_f32_16x16x32_bf16 v[24:27], v[244:247], v[20:23], v[24:27]
  v_perm_b32 v16, v127, v127, v8
  v_perm_b32 v17, v127, v127, v9
  v_perm_b32 v18, v127, v127, v10
  v_perm_b32 v19, v127, v127, v11
  s_nop 1
  v_mfma_f32_16x16x32_bf16 v[24:27], v[248:251], v[16:19], v[24:27]
  v_perm_b32 v20, v127, v127, v12
  v_perm_b32 v21, v127, v127, v13
  v_perm_b32 v22, v127, v127, v14
  v_perm_b32 v23, v127, v127, v15
  s_nop 1
  v_mfma_f32_16x16x32_bf16 v[24:27], v[252:255], v[20:23], v[24:27]
  v_lshlrev_b32 v30, 1, v7
  v_lshl_add_u32 v30, v1, 2, v30
  s_lshl_b32 s24, s63, 10
  s_add_u32 s24, s24, 139264
  v_add_u32 v30, s24, v30
  s_nop 2
  ds_write_b32 v30, v24 offset:0
  ds_write_b32 v30, v25 offset:32
  ds_write_b32 v30, v26 offset:64
  ds_write_b32 v30, v27 offset:96
  v_mov_b32 v29, 153100
  v_mov_b32 v28, 1
  s_waitcnt lgkmcnt(0)
  s_mov_b64 exec, 1
  ds_add_u32 v29, v28
  s_mov_b64 exec, -1
  s_cmp_lg_u32 s3, 4
  s_cbranch_scc1 L_fin
L_final:
  s_mov_b32 s8, s54
  s_mov_b32 s9, s55
  s_mov_b32 s10, 0x400
  s_mov_b32 s11, 0x20000
  buffer_load_dwordx4 v[32:35], v2, s[20:23], 0 offen
  buffer_load_dwordx4 v[36:39], v2, s[20:23], 0 offen offset:1024
  buffer_load_dwordx4 v[40:43], v2, s[8:11], 0 offen
  s_lshl_b32 s77, s5, 13
  s_add_u32 s77, s77, 1835008
  s_add_u32 s78, s77, 4096
  s_mov_b32 s75, 0
  v_mov_b32 v44, 153108
  s_waitcnt vmcnt(0)
  v_lshlrev_b32 v64, 16, v40
  v_and_b32 v65, 0xffff0000, v40
  v_lshlrev_b32 v66, 16, v41
  v_and_b32 v67, 0xffff0000, v41
  v_lshlrev_b32 v68, 16, v42
  v_and_b32 v69, 0xffff0000, v42
  v_lshlrev_b32 v70, 16, v43
  v_and_b32 v71, 0xffff0000, v43
  v_lshlrev_b32 v48, 16, v32
  v_and_b32 v49, 0xffff0000, v32
  v_lshlrev_b32 v50, 16, v33
  v_and_b32 v51, 0xffff0000, v33
  v_lshlrev_b32 v52, 16, v34
  v_and_b32 v53, 0xffff0000, v34
  v_lshlrev_b32 v54, 16, v35
  v_and_b32 v55, 0xffff0000, v35
  v_mul_f32 v48, v48, v64
  v_mul_f32 v49, v49, v65
  v_mul_f32 v50, v50, v66
  v_mul_f32 v51, v51, v67
  v_mul_f32 v52, v52, v68
  v_mul_f32 v53, v53, v69
  v_mul_f32 v54, v54, v70
  v_mul_f32 v55, v55, v71
  v_cvt_pk_bf16_f32 v72, v48, v49
  v_cvt_pk_bf16_f32 v73, v50, v51
  v_cvt_pk_bf16_f32 v74, v52, v53
  v_cvt_pk_bf16_f32 v75, v54, v55
  v_lshlrev_b32 v48, 16, v72
  v_and_b32 v49, 0xffff0000, v72
  v_lshlrev_b32 v50, 16, v73
  v_and_b32 v51, 0xffff0000, v73
  v_lshlrev_b32 v52, 16, v74
  v_and_b32 v53, 0xffff0000, v74
  v_lshlrev_b32 v54, 16, v75
  v_and_b32 v55, 0xffff0000, v75
  v_add_f32 v48, v48, v52
  v_add_f32 v49, v49, v53
  v_add_f32 v50, v50, v54
  v_add_f32 v51, v51, v55
  v_add_f32 v48, v48, v50
  v_add_f32 v49, v49, v51
  v_add_f32 v48, v48, v49
  s_nop 1
  v_add_f32_dpp v48, v48, v48 row_ror:8 row_mask:0xf bank_mask:0xf
  s_nop 1
  v_add_f32_dpp v48, v48, v48 row_ror:4 row_mask:0xf bank_mask:0xf
  s_nop 1
  v_add_f32_dpp v48, v48, v48 row_ror:2 row_mask:0xf bank_mask:0xf
  s_nop 1
  v_add_f32_dpp v48, v48, v48 row_ror:1 row_mask:0xf bank_mask:0xf
  v_mov_b32 v49, v48
  s_nop 1
  v_permlane16_swap_b32 v48, v49
  v_add_f32 v48, v48, v49
  v_mov_b32 v49, v48
  s_nop 1
  v_permlane32_swap_b32 v48, v49
  v_add_f32 v48, v48, v49
  v_lshlrev_b32 v56, 16, v36
  v_and_b32 v57, 0xffff0000, v36
  v_lshlrev_b32 v58, 16, v37
  v_and_b32 v59, 0xffff0000, v37
  v_lshlrev_b32 v60, 16, v38
  v_and_b32 v61, 0xffff0000, v38
  v_lshlrev_b32 v62, 16, v39
  v_and_b32 v63, 0xffff0000, v39
  v_mul_f32 v56, v56, v64
  v_mul_f32 v57, v57, v65
  v_mul_f32 v58, v58, v66
  v_mul_f32 v59, v59, v67
  v_mul_f32 v60, v60, v68
  v_mul_f32 v61, v61, v69
  v_mul_f32 v62, v62, v70
  v_mul_f32 v63, v63, v71
  v_cvt_pk_bf16_f32 v72, v56, v57
  v_cvt_pk_bf16_f32 v73, v58, v59
  v_cvt_pk_bf16_f32 v74, v60, v61
  v_cvt_pk_bf16_f32 v75, v62, v63
  v_lshlrev_b32 v56, 16, v72
  v_and_b32 v57, 0xffff0000, v72
  v_lshlrev_b32 v58, 16, v73
  v_and_b32 v59, 0xffff0000, v73
  v_lshlrev_b32 v60, 16, v74
  v_and_b32 v61, 0xffff0000, v74
  v_lshlrev_b32 v62, 16, v75
  v_and_b32 v63, 0xffff0000, v75
  v_add_f32 v56, v56, v60
  v_add_f32 v57, v57, v61
  v_add_f32 v58, v58, v62
  v_add_f32 v59, v59, v63
  v_add_f32 v56, v56, v58
  v_add_f32 v57, v57, v59
  v_add_f32 v56, v56, v57
  s_nop 1
  v_add_f32_dpp v56, v56, v56 row_ror:8 row_mask:0xf bank_mask:0xf
  s_nop 1
  v_add_f32_dpp v56, v56, v56 row_ror:4 row_mask:0xf bank_mask:0xf
  s_nop 1
  v_add_f32_dpp v56, v56, v56 row_ror:2 row_mask:0xf bank_mask:0xf
  s_nop 1
  v_add_f32_dpp v56, v56, v56 row_ror:1 row_mask:0xf bank_mask:0xf
  v_mov_b32 v57, v56
  s_nop 1
  v_permlane16_swap_b32 v56, v57
  v_add_f32 v56, v56, v57
  v_mov_b32 v57, v56
  s_nop 1
  v_permlane32_swap_b32 v56, v57
  v_add_f32 v56, v56, v57
  v_and_b32 v28, 8, v0
  v_cmp_eq_u32 vcc, 0, v28
  s_nop 1
  v_cndmask_b32 v48, v56, v48, vcc
  v_cvt_pk_bf16_f32 v48, v48, v48
  v_lshlrev_b32 v48, 16, v48
  v_mul_f32 v48, 0xbfb8aa3b, v48
  v_exp_f32 v48, v48
  s_nop 0
  v_add_f32 v48, 1.0, v48
  v_rcp_f32 v48, v48
  s_nop 0
  v_cvt_pk_bf16_f32 v48, v48, v48
  v_lshlrev_b32 v40, 16, v48
  v_sub_f32 v41, 1.0, v40
  v_cvt_pk_bf16_f32 v41, v41, v41
  v_lshlrev_b32 v41, 16, v41
L_fph:
  s_mov_b32 s30, 50000
L_lp21:
  ds_read_b32 v28, v44
  s_waitcnt lgkmcnt(0)
  v_readfirstlane_b32 s31, v28
  s_cmp_ge_u32 s31, 1
  s_cbranch_scc1 L_lpd22
  s_sleep 4
  s_sub_u32 s30, s30, 1
  s_cmp_lg_u32 s30, 0
  s_cbranch_scc1 L_lp21
L_lpd22:
  s_mov_b32 s30, 50000
L_gp23:
  buffer_load_dwordx4 v[48:51], v2, s[16:19], s77 offen offset:0 sc1
  buffer_load_dwordx4 v[52:55], v2, s[16:19], s77 offen offset:1024 sc1
  buffer_load_dwordx4 v[56:59], v2, s[16:19], s77 offen offset:2048 sc1
  buffer_load_dwordx4 v[60:63], v2, s[16:19], s77 offen offset:3072 sc1
  buffer_load_dwordx4 v[64:67], v2, s[16:19], s78 offen offset:0 sc1
  buffer_load_dwordx4 v[68:71], v2, s[16:19], s78 offen offset:1024 sc1
  buffer_load_dwordx4 v[72:75], v2, s[16:19], s78 offen offset:2048 sc1
  buffer_load_dwordx4 v[76:79], v2, s[16:19], s78 offen offset:3072 sc1
  s_waitcnt vmcnt(0)
  v_mov_b32 v28, v49
  v_mov_b32 v29, v49
  v_min3_u32 v28, v28, v51, v53
  v_max3_u32 v29, v29, v51, v53
  v_min3_u32 v28, v28, v55, v57
  v_max3_u32 v29, v29, v55, v57
  v_min3_u32 v28, v28, v59, v61
  v_max3_u32 v29, v29, v59, v61
  v_min3_u32 v28, v28, v63, v65
  v_max3_u32 v29, v29, v63, v65
  v_min3_u32 v28, v28, v67, v69
  v_max3_u32 v29, v29, v67, v69
  v_min3_u32 v28, v28, v71, v73
  v_max3_u32 v29, v29, v71, v73
  v_min3_u32 v28, v28, v75, v77
  v_max3_u32 v29, v29, v75, v77
  v_min3_u32 v28, v28, v79, v79
  v_max3_u32 v29, v29, v79, v79
  v_cmp_eq_u32 s[24:25], s7, v28
  v_cmp_eq_u32 vcc, s7, v29
  s_and_b64 vcc, vcc, s[24:25]
  s_cmp_eq_u64 vcc, -1
  s_cbranch_scc1 L_gpd24
  s_sleep 1
  s_sub_u32 s30, s30, 1
  s_cmp_lg_u32 s30, 0
  s_cbranch_scc1 L_gp23
L_gpd24:
  v_add_f32 v48, v48, v64
  v_add_f32 v50, v50, v66
  v_add_f32 v52, v52, v68
  v_add_f32 v54, v54, v70
  v_add_f32 v56, v56, v72
  v_add_f32 v58, v58, v74
  v_add_f32 v60, v60, v76
  v_add_f32 v62, v62, v78
  v_add_f32 v48, v48, v56
  v_add_f32 v50, v50, v58
  v_add_f32 v52, v52, v60
  v_add_f32 v54, v54, v62
  v_add_f32 v48, v48, v52
  v_add_f32 v50, v50, v54
  v_mov_b32 v36, v48
  s_nop 1
  v_permlane16_swap_b32 v48, v36
  v_add_f32 v48, v48, v36
  v_mov_b32 v36, v48
  s_nop 1
  v_permlane32_swap_b32 v48, v36
  v_add_f32 v48, v48, v36
  v_mov_b32 v36, v50
  s_nop 1
  v_permlane16_swap_b32 v50, v36
  v_add_f32 v50, v50, v36
  v_mov_b32 v36, v50
  s_nop 1
  v_permlane32_swap_b32 v50, v36
  v_add_f32 v50, v50, v36
  v_cvt_pk_bf16_f32 v32, v48, v50
  v_and_b32 v33, 0xffff0000, v32
  v_lshlrev_b32 v32, 16, v32
  v_mul_f32 v32, v41, v32
  v_mul_f32 v33, v41, v33
  v_cvt_pk_bf16_f32 v32, v32, v33
  v_and_b32 v33, 0xffff0000, v32
  v_lshlrev_b32 v32, 16, v32
  s_cmp_lg_u32 s75, 0
  s_cbranch_scc1 L_fout
  v_mov_b32 v42, v32
  v_mov_b32 v43, v33
  v_mov_b32 v41, v40
  v_mov_b32 v44, 153108
  s_mov_b32 s75, 1
  s_add_u32 s77, s77, 262144
  s_add_u32 s78, s78, 262144
  s_branch L_fph
L_fout:
  v_add_f32 v32, v32, v42
  v_add_f32 v33, v33, v43
  v_cvt_pk_bf16_f32 v32, v32, v33
  s_mov_b32 s8, s56
  s_mov_b32 s9, s57
  s_mov_b32 s10, 0x800
  s_mov_b32 s11, 0x20000
  s_lshl_b32 s24, s5, 5
  v_lshrrev_b32 v33, 3, v4
  v_lshlrev_b32 v33, 10, v33
  v_lshl_add_u32 v33, v1, 1, v33
  s_mov_b64 exec, 0xffff
  buffer_store_short v32, v33, s[8:11], s24 offen
  buffer_store_short_d16_hi v32, v33, s[8:11], s24 offen offset:16
  s_cmp_lg_u32 s5, 0
  s_cbranch_scc1 L_fe
  s_mov_b64 exec, 1
  s_sub_u32 s24, s7, 0x9e3779b0
  v_mov_b32 v1, s24
  buffer_store_dword v1, off, s[16:19], s81 sc0 sc1
L_fe:
  s_mov_b64 exec, -1
L_fin:
L_end:
s_endpgm
.section .rodata,"a"
.p2align 6
.amdhsa_kernel gated_mix__mha_block_cached__compressed_kv_cla__decode_kernel
  .amdhsa_next_free_vgpr 256
  .amdhsa_next_free_sgpr 102
  .amdhsa_accum_offset 256
  .amdhsa_group_segment_fixed_size 0
  .amdhsa_kernarg_size 120
  .amdhsa_user_sgpr_count 2
  .amdhsa_user_sgpr_kernarg_segment_ptr 1
  .amdhsa_system_sgpr_workgroup_id_x 1
.end_amdhsa_kernel
```
